```python
import torch

def _softmax(x, axis=-1):
    return torch.softmax(x, dim=axis)
def _gelu(x):
    return torch.nn.functional.gelu(x, approximate="tanh")
def _silu(x):
    return torch.nn.functional.silu(x)
def _sigmoid(x):
    return torch.sigmoid(x)
def _layernorm(x, axis=-1, eps=1e-5):
    m = x.mean(dim=axis, keepdim=True)
    v = x.var(dim=axis, keepdim=True, unbiased=False)
    return (x - m) / torch.sqrt(v + eps)
def _scatter_add(tgt, idx, src, axis=0):
    return tgt.clone().index_add_(axis, idx, src)
def _segment_sum(src, seg, n):
    out = torch.zeros((n,) + src.shape[1:], dtype=src.dtype)
    return out.index_add_(0, seg, src)
def _pad(x, pw):
    flat = tuple(v for pair in reversed(pw) for v in pair)
    return torch.nn.functional.pad(x, flat)

kernel_name = 'concat_heads__sliding_block_cached__mha_block_cached__decode'

def setup_inputs():

    _w = (lambda a: (lambda t: t.to(torch.bfloat16) if t.is_floating_point() else t)(torch.as_tensor(a)))
    def _A_setup():
        B, Sq, D = 1, 1, 448
        Hq, Hkv, Sk, Dh = 16, 8, 8192, 256
        assert Hq % Hkv == 0, (Hq, Hkv)
        return {
            "x": _w((lambda *s: torch.randn(*s, dtype=torch.bfloat16) * 0.8)(B, Sq, D)),
            "k_cache": _w((lambda *s: torch.randn(*s, dtype=torch.bfloat16) * 1.6)(B, Hkv, Sk, Dh)),
            "v_cache": _w((lambda *s: torch.randn(*s, dtype=torch.bfloat16) * 0.2)(B, Hkv, Sk, Dh)),
            "wq": _w((lambda *s: torch.randn(*s, dtype=torch.bfloat16) * 1.6)(D, Hq * Dh) * (D ** -0.5)),
            "wo": _w((lambda *s: torch.randn(*s, dtype=torch.bfloat16) * 0.2)(Hq * Dh, D) * ((Hq * Dh) ** -0.5)),
        }
    _A_in = _A_setup()

    def _B_setup():
        B, Sq, D = 1, 1, 448
        H, Sk, Dh = 16, 8192, 256
        return {
            "x": _w((lambda *s: torch.randn(*s, dtype=torch.bfloat16) * 0.8)(B, Sq, D)),
            "k_cache": _w((lambda *s: torch.randn(*s, dtype=torch.bfloat16) * 1.6)(B, H, Sk, Dh)),
            "v_cache": _w((lambda *s: torch.randn(*s, dtype=torch.bfloat16) * 0.2)(B, H, Sk, Dh)),
            "wq": _w((lambda *s: torch.randn(*s, dtype=torch.bfloat16) * 1.6)(D, H * Dh) * (D ** -0.5)),
            "wo": _w((lambda *s: torch.randn(*s, dtype=torch.bfloat16) * 0.2)(H * Dh, D) * ((H * Dh) ** -0.5)),
        }
    _B_in = _B_setup()

    return {
        "A_x": _A_in["x"],
        "A_k_cache": _A_in["k_cache"],
        "A_v_cache": _A_in["v_cache"],
        "A_wq": _A_in["wq"],
        "A_wo": _A_in["wo"],
        "B_x": _B_in["x"],
        "B_k_cache": _B_in["k_cache"],
        "B_v_cache": _B_in["v_cache"],
        "B_wq": _B_in["wq"],
        "B_wo": _B_in["wo"],
    }

def reference(A_x, A_k_cache, A_v_cache, A_wq, A_wo, B_x, B_k_cache, B_v_cache, B_wq, B_wo):
    def _A_ref(x, k_cache, v_cache, wq, wo):
        B, Sq, D = x.shape
        Hq, Dh = 16, 256
        Hkv, Sk = k_cache.shape[1], k_cache.shape[2]
        W = min(4096, max(256, Sk // 4))
        rep = Hq // Hkv
        q = (lambda x, *d: x.permute(*d))((x @ wq).reshape(B, Sq, Hq, Dh), 0, 2, 1, 3)
        k = (lambda x, n, axis: torch.repeat_interleave(x, n, dim=axis))(k_cache[:, :, Sk - W:, :], rep, axis=1)
        v = (lambda x, n, axis: torch.repeat_interleave(x, n, dim=axis))(v_cache[:, :, Sk - W:, :], rep, axis=1)
        scores = torch.einsum("bhqd,bhkd->bhqk", q, k) * (Dh ** -0.5)
        p = _softmax(scores, axis=-1)
        o = torch.einsum("bhqk,bhkd->bhqd", p, v)
        return (lambda x, *d: x.permute(*d))(o, 0, 2, 1, 3).reshape(B, Sq, Hq * Dh) @ wo

    def _B_ref(x, k_cache, v_cache, wq, wo):
        B, Sq, D = x.shape
        H, Dh = 16, 256
        q = (lambda x, *d: x.permute(*d))((x @ wq).reshape(B, Sq, H, Dh), 0, 2, 1, 3)
        scores = torch.einsum("bhqd,bhkd->bhqk", q, k_cache) * (Dh ** -0.5)
        p = _softmax(scores, axis=-1)
        o = torch.einsum("bhqk,bhkd->bhqd", p, v_cache)
        return (lambda x, *d: x.permute(*d))(o, 0, 2, 1, 3).reshape(B, Sq, H * Dh) @ wo

    a = _A_ref(A_x, A_k_cache, A_v_cache, A_wq, A_wo)
    b = _B_ref(B_x, B_k_cache, B_v_cache, B_wq, B_wo)
    return torch.concatenate([a, b], axis=-1)
```

```asm
; @launch grid=(256,1,1) block=(512,1,1) lds=8192
.amdgcn_target "amdgcn-amd-amdhsa--gfx950"
.text
.globl concat_heads__sliding_block_cached__mha_block_cached__decode_kernel
.p2align 8
.type concat_heads__sliding_block_cached__mha_block_cached__decode_kernel,@function
concat_heads__sliding_block_cached__mha_block_cached__decode_kernel:
    s_load_dwordx16 s[4:19], s[0:1], 0
    s_load_dwordx8 s[20:27], s[0:1], 64
    s_load_dwordx2 s[28:29], s[0:1], 96
    v_lshrrev_b32 v2, 6, v0
    s_cmp_ge_u32 s2, 256
    v_readfirstlane_b32 s68, v2
    s_cbranch_scc1 L_end
    v_and_b32 v0, 63, v0
    v_lshlrev_b32 v1, 4, v0
    s_and_b32 s3, s68, 3
    s_and_b32 s72, s2, 7
    s_lshr_b32 s2, s2, 3
    s_lshl_b32 s78, s72, 5
    s_or_b32 s2, s2, s78
    s_cmp_ge_u32 s68, 4
    s_cbranch_scc1 L_hprog
    s_lshl_b32 s77, s3, 12
    s_lshl_b32 s78, s2, 18
    s_and_b32 s44, s78, 0x3c00000
    s_add_u32 s40, s44, s77
    s_mov_b32 s42, 4182016
    s_mov_b32 s43, 0x20000
    s_waitcnt lgkmcnt(0)
    s_add_u32 s40, s16, s40
    s_addc_u32 s41, s17, 0
    s_and_b32 s26, s78, 0x3c0000
    buffer_load_dwordx4 v[100:103], v1, s[40:43], s26 offen offset:0 nt
    buffer_load_dwordx4 v[104:107], v1, s[40:43], s26 offen offset:1024 nt
    buffer_load_dwordx4 v[108:111], v1, s[40:43], s26 offen offset:2048 nt
    s_bfe_u32 s82, s2, 0x10004
    s_add_u32 s74, s2, s72
    s_add_u32 s74, s74, s82
    s_and_b32 s74, s74, 7
    s_bfe_u32 s73, s2, 0x10003
    s_lshl2_add_u32 s78, s73, s3
    s_mulk_i32 s78, 56
    s_lshl3_add_u32 s79, s72, s74
    s_lshl_b32 s79, s79, 7
    s_lshl_b32 s48, s78, 13
    s_add_u32 s48, s48, s79
    s_mov_b32 s50, 450688
    s_mov_b32 s51, 0x20000
    v_lshrrev_b32 v2, 3, v0
    v_and_b32 v3, 7, v0
    v_mul_u32_u24 v4, 57344, v2
    v_lshl_add_u32 v4, v3, 4, v4
    s_cmp_eq_u32 s82, 0
    s_cselect_b64 s[70:71], s[10:11], s[20:21]
    s_cselect_b64 s[84:85], s[4:5], s[14:15]
    s_add_u32 s48, s70, s48
    s_addc_u32 s49, s71, 0
    buffer_load_dwordx4 v[36:39], v4, s[48:51], 0 offen nt
    buffer_load_dwordx4 v[112:115], v1, s[40:43], s26 offen offset:3072 nt
    s_lshl_b32 s52, s78, 1
    s_sub_u32 s54, 896, s52
    s_mov_b32 s55, 0x20000
    s_add_u32 s52, s84, s52
    s_addc_u32 s53, s85, 0
    v_mul_u32_u24 v5, 14, v2
    buffer_load_dwordx3 v[80:82], v5, s[52:55], 0 offen
    buffer_load_ushort v83, v5, s[52:55], 0 offen offset:12
    s_setprio 2
    s_mov_b32 s100, 0x05040100
    s_mov_b32 s101, 0x07060302
    v_lshl_add_u32 v5, v3, 3, v2
    s_lshl_b32 s78, s3, 8
    v_lshl_add_u32 v5, v5, 2, s78
    s_waitcnt vmcnt(6)
    s_mov_b32 s81, 8192
    buffer_load_dwordx4 v[40:43], v4, s[48:51], s81 offen nt
    s_waitcnt vmcnt(6)
    s_add_u32 s86, s26, 0x144000
    s_and_b32 s86, s86, 0x3fffff
    buffer_load_dwordx4 v[116:119], v1, s[40:43], s86 offen offset:0 nt
    s_waitcnt vmcnt(6)
    s_mov_b32 s81, 16384
    buffer_load_dwordx4 v[44:47], v4, s[48:51], s81 offen nt
    s_waitcnt vmcnt(6)
    buffer_load_dwordx4 v[120:123], v1, s[40:43], s86 offen offset:1024 nt
    s_waitcnt vmcnt(6)
    s_mov_b32 s81, 24576
    buffer_load_dwordx4 v[48:51], v4, s[48:51], s81 offen nt
    s_waitcnt vmcnt(4)
    buffer_load_dwordx4 v[124:127], v1, s[40:43], s86 offen offset:2048 nt
    v_perm_b32 v84, v40, v36, s100
    v_perm_b32 v85, v40, v36, s101
    v_perm_b32 v86, v41, v37, s100
    v_perm_b32 v87, v41, v37, s101
    v_perm_b32 v88, v42, v38, s100
    v_perm_b32 v89, v42, v38, s101
    v_perm_b32 v90, v43, v39, s100
    v_perm_b32 v91, v43, v39, s101
    v_dot2_f32_bf16 v28, v84, v80, 0
    v_dot2_f32_bf16 v29, v85, v80, 0
    v_dot2_f32_bf16 v30, v86, v80, 0
    v_dot2_f32_bf16 v31, v87, v80, 0
    v_dot2_f32_bf16 v32, v88, v80, 0
    v_dot2_f32_bf16 v33, v89, v80, 0
    v_dot2_f32_bf16 v34, v90, v80, 0
    v_dot2_f32_bf16 v35, v91, v80, 0
    s_waitcnt vmcnt(4)
    s_mov_b32 s81, 32768
    buffer_load_dwordx4 v[52:55], v4, s[48:51], s81 offen nt
    s_waitcnt vmcnt(4)
    buffer_load_dwordx4 v[128:131], v1, s[40:43], s86 offen offset:3072 nt
    s_waitcnt vmcnt(4)
    s_mov_b32 s81, 40960
    buffer_load_dwordx4 v[56:59], v4, s[48:51], s81 offen nt
    s_waitcnt vmcnt(4)
    s_add_u32 s86, s86, 0x144000
    s_and_b32 s86, s86, 0x3fffff
    buffer_load_dwordx4 v[132:135], v1, s[40:43], s86 offen offset:0 nt
    v_perm_b32 v84, v48, v44, s100
    v_perm_b32 v85, v48, v44, s101
    v_perm_b32 v86, v49, v45, s100
    v_perm_b32 v87, v49, v45, s101
    v_perm_b32 v88, v50, v46, s100
    v_perm_b32 v89, v50, v46, s101
    v_perm_b32 v90, v51, v47, s100
    v_perm_b32 v91, v51, v47, s101
    v_dot2_f32_bf16 v28, v84, v81, v28
    v_dot2_f32_bf16 v29, v85, v81, v29
    v_dot2_f32_bf16 v30, v86, v81, v30
    v_dot2_f32_bf16 v31, v87, v81, v31
    v_dot2_f32_bf16 v32, v88, v81, v32
    v_dot2_f32_bf16 v33, v89, v81, v33
    v_dot2_f32_bf16 v34, v90, v81, v34
    v_dot2_f32_bf16 v35, v91, v81, v35
    s_waitcnt vmcnt(4)
    s_mov_b32 s81, 49152
    buffer_load_dwordx4 v[60:63], v4, s[48:51], s81 offen nt
    s_waitcnt vmcnt(4)
    buffer_load_dwordx4 v[136:139], v1, s[40:43], s86 offen offset:1024 nt
    s_waitcnt vmcnt(4)
    buffer_load_dwordx4 v[140:143], v1, s[40:43], s86 offen offset:2048 nt
    s_waitcnt vmcnt(4)
    buffer_load_dwordx4 v[144:147], v1, s[40:43], s86 offen offset:3072 nt
    v_perm_b32 v84, v56, v52, s100
    v_perm_b32 v85, v56, v52, s101
    v_perm_b32 v86, v57, v53, s100
    v_perm_b32 v87, v57, v53, s101
    v_perm_b32 v88, v58, v54, s100
    v_perm_b32 v89, v58, v54, s101
    v_perm_b32 v90, v59, v55, s100
    v_perm_b32 v91, v59, v55, s101
    v_dot2_f32_bf16 v28, v84, v82, v28
    v_dot2_f32_bf16 v29, v85, v82, v29
    v_dot2_f32_bf16 v30, v86, v82, v30
    v_dot2_f32_bf16 v31, v87, v82, v31
    v_dot2_f32_bf16 v32, v88, v82, v32
    v_dot2_f32_bf16 v33, v89, v82, v33
    v_dot2_f32_bf16 v34, v90, v82, v34
    v_dot2_f32_bf16 v35, v91, v82, v35
    s_waitcnt vmcnt(4)
    s_add_u32 s86, s86, 0x144000
    s_and_b32 s86, s86, 0x3fffff
    buffer_load_dwordx4 v[148:151], v1, s[40:43], s86 offen offset:0 nt
    s_waitcnt vmcnt(4)
    buffer_load_dwordx4 v[152:155], v1, s[40:43], s86 offen offset:1024 nt
    v_lshlrev_b32 v84, 16, v83
    v_dot2_f32_bf16 v28, v60, v83, v28
    v_dot2_f32_bf16 v30, v61, v83, v30
    v_dot2_f32_bf16 v32, v62, v83, v32
    v_dot2_f32_bf16 v34, v63, v83, v34
    v_dot2_f32_bf16 v29, v60, v84, v29
    v_dot2_f32_bf16 v31, v61, v84, v31
    v_dot2_f32_bf16 v33, v62, v84, v33
    v_dot2_f32_bf16 v35, v63, v84, v35
    v_permlane32_swap_b32 v28, v32
    s_nop 0
    v_permlane32_swap_b32 v29, v33
    v_permlane32_swap_b32 v30, v34
    v_permlane32_swap_b32 v31, v35
    v_pk_add_f32 v[28:29], v[28:29], v[32:33]
    v_pk_add_f32 v[30:31], v[30:31], v[34:35]
    s_nop 1
    v_permlane16_swap_b32 v28, v30
    v_permlane16_swap_b32 v29, v31
    v_pk_add_f32 v[28:29], v[28:29], v[30:31]
    s_nop 1
    v_add_f32_dpp v29, v29, v29 row_ror:8 row_mask:0xf bank_mask:0xc
    s_nop 1
    v_add_f32_dpp v29, v28, v28 row_ror:8 row_mask:0xf bank_mask:0x3
    ds_write_b32 v5, v29 offset:4160
    buffer_load_dwordx4 v[156:159], v1, s[40:43], s86 offen offset:2048 nt
    s_waitcnt lgkmcnt(0)
    s_barrier
    s_load_dword s30, s[28:29], 0
    s_waitcnt vmcnt(4)
    buffer_load_dwordx4 v[160:163], v1, s[40:43], s86 offen offset:3072 nt
    s_lshl_b32 s36, s72, 22
    s_and_b32 s78, s2, 31
    s_lshl_b32 s78, s78, 15
    s_add_u32 s36, s36, s78
    s_add_u32 s36, s36, 3145728
    s_add_u32 s32, s36, s77
    s_mov_b32 s34, 20480
    s_mov_b32 s35, 0x20000
    s_add_u32 s32, s6, s32
    s_addc_u32 s33, s7, 0
    s_lshl_b32 s77, s3, 7
    s_add_u32 s36, s36, s77
    s_add_u32 s44, s44, s77
    s_mov_b32 s38, 32384
    s_mov_b32 s39, 0x20000
    s_add_u32 s36, s8, s36
    s_addc_u32 s37, s9, 0
    s_mov_b32 s46, 4193920
    s_mov_b32 s47, 0x20000
    s_add_u32 s44, s18, s44
    s_addc_u32 s45, s19, 0
    s_mov_b32 s27, 0x4000
    s_waitcnt vmcnt(4)
    s_add_u32 s86, s86, 0x144000
    s_and_b32 s86, s86, 0x3fffff
    buffer_load_dwordx4 v[164:167], v1, s[40:43], s86 offen offset:0 nt
    s_mov_b32 s60, s28
    s_mov_b32 s61, s29
    s_mov_b32 s62, 2097152
    s_mov_b32 s63, 0x20000
    s_mov_b32 s90, 0x3db8aa3b
    s_mov_b32 s91, 4000000
    s_mov_b32 s31, 0xffffff00
    v_lshlrev_b32 v11, 2, v0
    v_mov_b32 v95, 0
    v_mov_b32 v98, 1
    v_lshrrev_b32 v2, 3, v0
    v_and_b32 v3, 3, v0
    v_xor_b32 v3, s3, v3
    v_lshl_add_u32 v2, v2, 2, v3
    v_mul_u32_u24 v97, 80, v2
    s_and_b32 s75, s2, 7
    s_bfe_u32 s76, s2, 0x10003
    v_lshrrev_b32 v2, 3, v0
    v_and_b32 v3, 7, v0
    v_lshlrev_b32 v6, 9, v2
    v_lshl_add_u32 v6, v3, 4, v6
    s_lshl_b32 s78, s3, 12
    v_or_b32 v6, s78, v6
    v_xor_b32 v7, 4096, v6
    v_xor_b32 v8, 8192, v6
    v_xor_b32 v9, 12288, v6
    s_waitcnt vmcnt(4)
    buffer_load_dwordx4 v[168:171], v1, s[40:43], s86 offen offset:1024 nt
    v_bfe_u32 v2, v0, 2, 2
    v_lshrrev_b32 v3, 5, v0
    v_lshl_add_u32 v2, v2, 1, v3
    v_lshl_add_u32 v2, v2, 2, s3
    v_mul_u32_u24 v96, 80, v2
    s_mul_i32 s87, s2, 3200
    s_lshl_b32 s79, s3, 8
    s_add_u32 s87, s87, s79
    s_add_u32 s87, s87, 69632
    v_and_b32 v14, 31, v0
    v_lshlrev_b32 v14, 4, v14
    v_mov_b32 v28, 0
    v_mov_b32 v29, 0
    v_mov_b32 v30, 0
    v_mov_b32 v31, 0
    v_mov_b32 v32, 0
    v_mov_b32 v33, 0
    v_mov_b32 v34, 0
    v_mov_b32 v35, 0
    v_mov_b32 v36, 0
    v_mov_b32 v37, 0
    v_mov_b32 v38, 0
    v_mov_b32 v39, 0
    v_mov_b32 v40, 0
    v_mov_b32 v41, 0
    v_mov_b32 v42, 0
    v_mov_b32 v43, 0
    v_mov_b32 v44, 0
    v_mov_b32 v45, 0
    v_mov_b32 v46, 0
    v_mov_b32 v47, 0
    v_mov_b32 v48, 0
    v_mov_b32 v49, 0
    v_mov_b32 v50, 0
    v_mov_b32 v51, 0
    s_waitcnt vmcnt(4)
    buffer_load_dwordx4 v[172:175], v1, s[40:43], s86 offen offset:2048 nt
    v_lshrrev_b32 v2, 3, v0
    v_and_b32 v3, 7, v0
    v_lshlrev_b32 v99, 4, v2
    v_mul_u32_u24 v12, 3200, v2
    v_lshl_add_u32 v12, v3, 4, v12
    v_lshrrev_b32 v4, 4, v0
    v_and_b32 v2, 1, v2
    v_lshl_add_u32 v2, v4, 2, v2
    v_mul_u32_u24 v10, 1792, v2
    v_lshl_add_u32 v10, v3, 4, v10
    v_lshrrev_b32 v2, 1, v0
    v_and_b32 v3, 1, v0
    v_mul_u32_u24 v13, 1920, v2
    v_lshl_add_u32 v13, v3, 4, v13
    v_lshlrev_b32 v3, 6, v3
    v_lshl_add_u32 v76, v4, 4, v3
    s_lshl2_add_u32 s83, s76, s3
    s_lshr_b32 s77, s2, 4
    s_lshl_b32 s78, s77, 8
    s_lshr_b32 s79, s83, 1
    s_lshl_b32 s79, s79, 6
    s_add_u32 s78, s78, s79
    s_and_b32 s79, s83, 1
    s_lshl2_add_u32 s78, s79, s78
    s_mulk_i32 s78, 896
    s_lshl_b32 s79, s75, 7
    s_add_u32 s78, s78, s79
    s_add_u32 s56, s12, s78
    s_addc_u32 s57, s13, 0
    s_cmp_eq_u32 s75, 7
    s_cselect_b32 s58, 0, 52992
    s_mov_b32 s59, 0x20000
    s_mov_b32 s89, 28672
    s_mov_b32 s64, s24
    s_mov_b32 s65, s25
    s_mov_b32 s66, 1792
    s_mov_b32 s67, 0x20000
    s_lshr_b32 s78, s2, 3
    s_mulk_i32 s78, 1920
    s_lshl_b32 s79, s75, 8
    s_add_u32 s78, s78, s79
    s_add_u32 s88, s78, 1048576
    s_lshl_b32 s79, s83, 7
    s_mul_i32 s80, s72, 102400
    s_add_u32 s80, s80, s79
    s_lshl_b32 s79, s82, 10
    s_add_u32 s80, s80, s79
    s_add_u32 s80, s80, 70656
    s_add_u32 s17, s80, 25600
    s_add_u32 s18, s80, 51200
    s_add_u32 s19, s80, 76800
    s_and_b32 s0, s2, 31
    s_lshl3_add_u32 s0, s0, s72
    s_lshl_b32 s10, s72, 8
    s_lshl_b32 s11, s75, 5
    s_add_u32 s10, s10, s11
    s_add_u32 s10, s10, 1048576
    s_lshl_b32 s12, s72, 6
    s_add_u32 s12, s12, s75
    s_lshl_b32 s12, s12, 1
    s_mov_b32 s14, 0x00030003
    s_mov_b32 s15, 0x00030003
    s_bfe_u32 s9, s2, 0x20003
    s_xor_b32 s9, s9, 2
    s_cmp_eq_u32 s72, 7
    s_cselect_b32 s9, 1, s9
    s_lshl_b32 s13, s3, 8
    v_add_u32 v77, s13, v11
    s_waitcnt vmcnt(4)
    buffer_load_dwordx4 v[176:179], v1, s[40:43], s86 offen offset:3072 nt
    s_waitcnt vmcnt(4)
    s_add_u32 s86, s86, 0x144000
    s_and_b32 s86, s86, 0x3fffff
    buffer_load_dwordx4 v[180:183], v1, s[40:43], s86 offen offset:0 nt
    s_waitcnt vmcnt(4)
    buffer_load_dwordx4 v[184:187], v1, s[40:43], s86 offen offset:1024 nt
    s_waitcnt lgkmcnt(0)
    s_add_u32 s30, s30, 0x6A09E667
    s_bfe_u32 s69, s30, 0x80000
    s_bfe_u32 s92, s30, 0x80008
    s_bfe_u32 s93, s30, 0x80010
    s_bfe_u32 s94, s30, 0x80018
    v_and_b32 v2, 3, v0
    v_lshlrev_b32 v2, 3, v2
    v_mov_b32 v3, s30
    v_bfe_u32 v94, v3, v2, 8
    s_waitcnt vmcnt(4)
    buffer_load_dwordx4 v[188:191], v1, s[40:43], s86 offen offset:2048 nt
    s_waitcnt vmcnt(4)
    buffer_load_dwordx4 v[192:195], v1, s[40:43], s86 offen offset:3072 nt
    s_waitcnt vmcnt(4)
    s_add_u32 s86, s86, 0x144000
    s_and_b32 s86, s86, 0x3fffff
    buffer_load_dwordx4 v[196:199], v1, s[40:43], s86 offen offset:0 nt
    s_waitcnt vmcnt(4)
    buffer_load_dwordx4 v[200:203], v1, s[40:43], s86 offen offset:1024 nt
    s_waitcnt vmcnt(4)
    buffer_load_dwordx4 v[204:207], v1, s[40:43], s86 offen offset:2048 nt
    ds_write_b32 v95, v98 offset:2572
    s_waitcnt vmcnt(4)
    buffer_load_dwordx4 v[208:211], v1, s[40:43], s86 offen offset:3072 nt
    s_waitcnt vmcnt(4)
    s_add_u32 s86, s86, 0x144000
    s_and_b32 s86, s86, 0x3fffff
    buffer_load_dwordx4 v[212:215], v1, s[40:43], s86 offen offset:0 nt
    s_waitcnt vmcnt(4)
    buffer_load_dwordx4 v[216:219], v1, s[40:43], s86 offen offset:1024 nt
    s_waitcnt vmcnt(4)
    buffer_load_dwordx4 v[220:223], v1, s[40:43], s86 offen offset:2048 nt
    s_waitcnt vmcnt(4)
    buffer_load_dwordx4 v[224:227], v1, s[40:43], s86 offen offset:3072 nt
    s_waitcnt vmcnt(4)
    s_add_u32 s86, s86, 0x144000
    s_and_b32 s86, s86, 0x3fffff
    buffer_load_dwordx4 v[228:231], v1, s[40:43], s86 offen offset:0 nt
    s_waitcnt vmcnt(4)
    buffer_load_dwordx4 v[232:235], v1, s[40:43], s86 offen offset:1024 nt
    s_waitcnt vmcnt(4)
    buffer_load_dwordx4 v[236:239], v1, s[40:43], s86 offen offset:2048 nt
    s_waitcnt vmcnt(4)
    buffer_load_dwordx4 v[240:243], v1, s[40:43], s86 offen offset:3072 nt
    s_waitcnt vmcnt(4)
    s_add_u32 s86, s86, 0x144000
    s_and_b32 s86, s86, 0x3fffff
    buffer_load_dwordx4 v[244:247], v1, s[40:43], s86 offen offset:0 nt
    s_waitcnt vmcnt(4)
    buffer_load_dwordx4 v[248:251], v1, s[40:43], s86 offen offset:1024 nt
    s_waitcnt vmcnt(4)
    buffer_load_dwordx4 v[252:255], v1, s[40:43], s86 offen offset:2048 nt
L_sq:
    ds_read_b32 v2, v95 offset:2560
    s_sub_u32 s91, s91, 1
    s_waitcnt lgkmcnt(0)
    v_cmp_ne_u32 vcc, 3, v2
    s_nop 4
    s_cbranch_vccz L_sq_ok
    s_sleep 1
    s_cmp_gt_i32 s91, 0
    s_cbranch_scc1 L_sq
L_sq_ok:
    ds_read_b128 v[16:19], v14 offset:2624
    ds_read_b128 v[20:23], v14 offset:3136
    ds_read_b128 v[24:27], v14 offset:3648
    s_waitcnt lgkmcnt(0)
    v_dot2_f32_bf16 v78, v100, v16, 0
    v_dot2_f32_bf16 v78, v101, v17, v78
    v_dot2_f32_bf16 v78, v102, v18, v78
    v_dot2_f32_bf16 v78, v103, v19, v78
    s_waitcnt vmcnt(4)
    buffer_load_dwordx4 v[100:103], v1, s[40:43], s86 offen offset:3072 nt
    v_dot2_f32_bf16 v79, v104, v16, 0
    v_dot2_f32_bf16 v79, v105, v17, v79
    v_dot2_f32_bf16 v79, v106, v18, v79
    v_dot2_f32_bf16 v79, v107, v19, v79
    v_dot2_f32_bf16 v80, v108, v16, 0
    v_dot2_f32_bf16 v80, v109, v17, v80
    v_dot2_f32_bf16 v80, v110, v18, v80
    v_dot2_f32_bf16 v80, v111, v19, v80
    v_add_f32_dpp v82, v78, v78 row_ror:8 row_mask:0xf bank_mask:0x3
    v_add_f32_dpp v83, v79, v79 row_ror:8 row_mask:0xf bank_mask:0x3
    s_waitcnt vmcnt(4)
    s_add_u32 s86, s86, 0x144000
    s_and_b32 s86, s86, 0x3fffff
    buffer_load_dwordx4 v[104:107], v1, s[40:43], s86 offen offset:0 nt
    v_dot2_f32_bf16 v81, v112, v16, 0
    v_dot2_f32_bf16 v81, v113, v17, v81
    v_dot2_f32_bf16 v81, v114, v18, v81
    v_dot2_f32_bf16 v81, v115, v19, v81
    v_add_f32_dpp v82, v80, v80 row_ror:8 row_mask:0xf bank_mask:0xc
    s_nop 1
    v_add_f32_dpp v83, v81, v81 row_ror:8 row_mask:0xf bank_mask:0xc
    v_add_f32_dpp v52, v82, v82 row_half_mirror row_mask:0xf bank_mask:0x5
    s_nop 1
    v_add_f32_dpp v52, v83, v83 row_half_mirror row_mask:0xf bank_mask:0xa
    s_nop 1
    v_add_f32_dpp v52, v52, v52 quad_perm:[1,0,3,2] row_mask:0xf bank_mask:0xf
    s_nop 1
    v_add_f32_dpp v52, v52, v52 quad_perm:[2,3,0,1] row_mask:0xf bank_mask:0xf
    v_mov_b32 v84, v52
    s_nop 1
    v_permlane16_swap_b32 v84, v52
    v_add_f32 v52, v52, v84
    v_dot2_f32_bf16 v78, v116, v16, 0
    v_dot2_f32_bf16 v78, v117, v17, v78
    v_dot2_f32_bf16 v78, v118, v18, v78
    v_dot2_f32_bf16 v78, v119, v19, v78
    s_waitcnt vmcnt(4)
    buffer_load_dwordx4 v[108:111], v1, s[40:43], s86 offen offset:1024 nt
    v_dot2_f32_bf16 v79, v120, v16, 0
    v_dot2_f32_bf16 v79, v121, v17, v79
    v_dot2_f32_bf16 v79, v122, v18, v79
    v_dot2_f32_bf16 v79, v123, v19, v79
    s_waitcnt vmcnt(4)
    buffer_load_dwordx4 v[112:115], v1, s[40:43], s86 offen offset:2048 nt
    v_dot2_f32_bf16 v80, v124, v16, 0
    v_dot2_f32_bf16 v80, v125, v17, v80
    v_dot2_f32_bf16 v80, v126, v18, v80
    v_dot2_f32_bf16 v80, v127, v19, v80
    v_add_f32_dpp v82, v78, v78 row_ror:8 row_mask:0xf bank_mask:0x3
    v_add_f32_dpp v83, v79, v79 row_ror:8 row_mask:0xf bank_mask:0x3
    v_dot2_f32_bf16 v81, v128, v16, 0
    v_dot2_f32_bf16 v81, v129, v17, v81
    v_dot2_f32_bf16 v81, v130, v18, v81
    v_dot2_f32_bf16 v81, v131, v19, v81
    v_add_f32_dpp v82, v80, v80 row_ror:8 row_mask:0xf bank_mask:0xc
    s_nop 1
    v_add_f32_dpp v83, v81, v81 row_ror:8 row_mask:0xf bank_mask:0xc
    v_add_f32_dpp v53, v82, v82 row_half_mirror row_mask:0xf bank_mask:0x5
    s_nop 1
    v_add_f32_dpp v53, v83, v83 row_half_mirror row_mask:0xf bank_mask:0xa
    s_nop 1
    v_add_f32_dpp v53, v53, v53 quad_perm:[1,0,3,2] row_mask:0xf bank_mask:0xf
    s_nop 1
    v_add_f32_dpp v53, v53, v53 quad_perm:[2,3,0,1] row_mask:0xf bank_mask:0xf
    v_mov_b32 v84, v53
    s_nop 1
    v_permlane16_swap_b32 v84, v53
    v_add_f32 v53, v53, v84
    s_waitcnt vmcnt(4)
    buffer_load_dwordx4 v[116:119], v1, s[40:43], s86 offen offset:3072 nt
    v_dot2_f32_bf16 v78, v132, v16, 0
    v_dot2_f32_bf16 v78, v133, v17, v78
    v_dot2_f32_bf16 v78, v134, v18, v78
    v_dot2_f32_bf16 v78, v135, v19, v78
    s_waitcnt vmcnt(4)
    s_add_u32 s86, s86, 0x144000
    s_and_b32 s86, s86, 0x3fffff
    buffer_load_dwordx4 v[120:123], v1, s[40:43], s86 offen offset:0 nt
    v_dot2_f32_bf16 v79, v136, v16, 0
    v_dot2_f32_bf16 v79, v137, v17, v79
    v_dot2_f32_bf16 v79, v138, v18, v79
    v_dot2_f32_bf16 v79, v139, v19, v79
    v_dot2_f32_bf16 v80, v140, v16, 0
    v_dot2_f32_bf16 v80, v141, v17, v80
    v_dot2_f32_bf16 v80, v142, v18, v80
    v_dot2_f32_bf16 v80, v143, v19, v80
    v_add_f32_dpp v82, v78, v78 row_ror:8 row_mask:0xf bank_mask:0x3
    v_add_f32_dpp v83, v79, v79 row_ror:8 row_mask:0xf bank_mask:0x3
    v_dot2_f32_bf16 v81, v144, v16, 0
    v_dot2_f32_bf16 v81, v145, v17, v81
    v_dot2_f32_bf16 v81, v146, v18, v81
    v_dot2_f32_bf16 v81, v147, v19, v81
    v_add_f32_dpp v82, v80, v80 row_ror:8 row_mask:0xf bank_mask:0xc
    s_nop 1
    v_add_f32_dpp v83, v81, v81 row_ror:8 row_mask:0xf bank_mask:0xc
    v_add_f32_dpp v54, v82, v82 row_half_mirror row_mask:0xf bank_mask:0x5
    s_nop 1
    v_add_f32_dpp v54, v83, v83 row_half_mirror row_mask:0xf bank_mask:0xa
    s_nop 1
    v_add_f32_dpp v54, v54, v54 quad_perm:[1,0,3,2] row_mask:0xf bank_mask:0xf
    s_nop 1
    v_add_f32_dpp v54, v54, v54 quad_perm:[2,3,0,1] row_mask:0xf bank_mask:0xf
    v_mov_b32 v84, v54
    s_nop 1
    v_permlane16_swap_b32 v84, v54
    v_add_f32 v54, v54, v84
    s_waitcnt vmcnt(4)
    buffer_load_dwordx4 v[124:127], v1, s[40:43], s86 offen offset:1024 nt
    v_dot2_f32_bf16 v78, v148, v16, 0
    v_dot2_f32_bf16 v78, v149, v17, v78
    v_dot2_f32_bf16 v78, v150, v18, v78
    v_dot2_f32_bf16 v78, v151, v19, v78
    v_dot2_f32_bf16 v79, v152, v16, 0
    v_dot2_f32_bf16 v79, v153, v17, v79
    v_dot2_f32_bf16 v79, v154, v18, v79
    v_dot2_f32_bf16 v79, v155, v19, v79
    v_dot2_f32_bf16 v80, v156, v16, 0
    v_dot2_f32_bf16 v80, v157, v17, v80
    v_dot2_f32_bf16 v80, v158, v18, v80
    v_dot2_f32_bf16 v80, v159, v19, v80
    v_add_f32_dpp v82, v78, v78 row_ror:8 row_mask:0xf bank_mask:0x3
    v_add_f32_dpp v83, v79, v79 row_ror:8 row_mask:0xf bank_mask:0x3
    s_waitcnt vmcnt(4)
    buffer_load_dwordx4 v[128:131], v1, s[40:43], s86 offen offset:2048 nt
    v_dot2_f32_bf16 v81, v160, v16, 0
    v_dot2_f32_bf16 v81, v161, v17, v81
    v_dot2_f32_bf16 v81, v162, v18, v81
    v_dot2_f32_bf16 v81, v163, v19, v81
    v_add_f32_dpp v82, v80, v80 row_ror:8 row_mask:0xf bank_mask:0xc
    s_nop 1
    v_add_f32_dpp v83, v81, v81 row_ror:8 row_mask:0xf bank_mask:0xc
    v_add_f32_dpp v55, v82, v82 row_half_mirror row_mask:0xf bank_mask:0x5
    s_nop 1
    v_add_f32_dpp v55, v83, v83 row_half_mirror row_mask:0xf bank_mask:0xa
    s_nop 1
    v_add_f32_dpp v55, v55, v55 quad_perm:[1,0,3,2] row_mask:0xf bank_mask:0xf
    s_nop 1
    v_add_f32_dpp v55, v55, v55 quad_perm:[2,3,0,1] row_mask:0xf bank_mask:0xf
    v_mov_b32 v84, v55
    s_nop 1
    v_permlane16_swap_b32 v84, v55
    v_add_f32 v55, v55, v84
    v_dot2_f32_bf16 v78, v164, v16, 0
    v_dot2_f32_bf16 v78, v165, v17, v78
    v_dot2_f32_bf16 v78, v166, v18, v78
    v_dot2_f32_bf16 v78, v167, v19, v78
    v_dot2_f32_bf16 v79, v168, v16, 0
    v_dot2_f32_bf16 v79, v169, v17, v79
    v_dot2_f32_bf16 v79, v170, v18, v79
    v_dot2_f32_bf16 v79, v171, v19, v79
    s_waitcnt vmcnt(4)
    buffer_load_dwordx4 v[132:135], v1, s[40:43], s86 offen offset:3072 nt
    v_dot2_f32_bf16 v80, v172, v16, 0
    v_dot2_f32_bf16 v80, v173, v17, v80
    v_dot2_f32_bf16 v80, v174, v18, v80
    v_dot2_f32_bf16 v80, v175, v19, v80
    v_add_f32_dpp v82, v78, v78 row_ror:8 row_mask:0xf bank_mask:0x3
    v_add_f32_dpp v83, v79, v79 row_ror:8 row_mask:0xf bank_mask:0x3
    v_dot2_f32_bf16 v81, v176, v16, 0
    v_dot2_f32_bf16 v81, v177, v17, v81
    v_dot2_f32_bf16 v81, v178, v18, v81
    v_dot2_f32_bf16 v81, v179, v19, v81
    v_add_f32_dpp v82, v80, v80 row_ror:8 row_mask:0xf bank_mask:0xc
    s_nop 1
    v_add_f32_dpp v83, v81, v81 row_ror:8 row_mask:0xf bank_mask:0xc
    v_add_f32_dpp v56, v82, v82 row_half_mirror row_mask:0xf bank_mask:0x5
    s_nop 1
    v_add_f32_dpp v56, v83, v83 row_half_mirror row_mask:0xf bank_mask:0xa
    s_nop 1
    v_add_f32_dpp v56, v56, v56 quad_perm:[1,0,3,2] row_mask:0xf bank_mask:0xf
    s_nop 1
    v_add_f32_dpp v56, v56, v56 quad_perm:[2,3,0,1] row_mask:0xf bank_mask:0xf
    v_mov_b32 v84, v56
    s_nop 1
    v_permlane16_swap_b32 v84, v56
    v_add_f32 v56, v56, v84
    v_dot2_f32_bf16 v78, v180, v16, 0
    v_dot2_f32_bf16 v78, v181, v17, v78
    v_dot2_f32_bf16 v78, v182, v18, v78
    v_dot2_f32_bf16 v78, v183, v19, v78
    s_waitcnt vmcnt(4)
    s_add_u32 s86, s86, 0x144000
    s_and_b32 s86, s86, 0x3fffff
    buffer_load_dwordx4 v[136:139], v1, s[40:43], s86 offen offset:0 nt
    v_dot2_f32_bf16 v79, v184, v16, 0
    v_dot2_f32_bf16 v79, v185, v17, v79
    v_dot2_f32_bf16 v79, v186, v18, v79
    v_dot2_f32_bf16 v79, v187, v19, v79
    v_dot2_f32_bf16 v80, v188, v16, 0
    v_dot2_f32_bf16 v80, v189, v17, v80
    v_dot2_f32_bf16 v80, v190, v18, v80
    v_dot2_f32_bf16 v80, v191, v19, v80
    v_add_f32_dpp v82, v78, v78 row_ror:8 row_mask:0xf bank_mask:0x3
    v_add_f32_dpp v83, v79, v79 row_ror:8 row_mask:0xf bank_mask:0x3
    v_dot2_f32_bf16 v81, v192, v16, 0
    v_dot2_f32_bf16 v81, v193, v17, v81
    v_dot2_f32_bf16 v81, v194, v18, v81
    v_dot2_f32_bf16 v81, v195, v19, v81
    v_add_f32_dpp v82, v80, v80 row_ror:8 row_mask:0xf bank_mask:0xc
    s_nop 1
    v_add_f32_dpp v83, v81, v81 row_ror:8 row_mask:0xf bank_mask:0xc
    v_add_f32_dpp v57, v82, v82 row_half_mirror row_mask:0xf bank_mask:0x5
    s_nop 1
    v_add_f32_dpp v57, v83, v83 row_half_mirror row_mask:0xf bank_mask:0xa
    s_nop 1
    v_add_f32_dpp v57, v57, v57 quad_perm:[1,0,3,2] row_mask:0xf bank_mask:0xf
    s_nop 1
    v_add_f32_dpp v57, v57, v57 quad_perm:[2,3,0,1] row_mask:0xf bank_mask:0xf
    v_mov_b32 v84, v57
    s_nop 1
    v_permlane16_swap_b32 v84, v57
    v_add_f32 v57, v57, v84
    s_waitcnt vmcnt(4)
    buffer_load_dwordx4 v[140:143], v1, s[40:43], s86 offen offset:1024 nt
    v_dot2_f32_bf16 v78, v196, v16, 0
    v_dot2_f32_bf16 v78, v197, v17, v78
    v_dot2_f32_bf16 v78, v198, v18, v78
    v_dot2_f32_bf16 v78, v199, v19, v78
    v_dot2_f32_bf16 v79, v200, v16, 0
    v_dot2_f32_bf16 v79, v201, v17, v79
    v_dot2_f32_bf16 v79, v202, v18, v79
    v_dot2_f32_bf16 v79, v203, v19, v79
    v_dot2_f32_bf16 v80, v204, v16, 0
    v_dot2_f32_bf16 v80, v205, v17, v80
    v_dot2_f32_bf16 v80, v206, v18, v80
    v_dot2_f32_bf16 v80, v207, v19, v80
    v_add_f32_dpp v82, v78, v78 row_ror:8 row_mask:0xf bank_mask:0x3
    v_add_f32_dpp v83, v79, v79 row_ror:8 row_mask:0xf bank_mask:0x3
    s_waitcnt vmcnt(4)
    buffer_load_dwordx4 v[144:147], v1, s[40:43], s86 offen offset:2048 nt
    v_dot2_f32_bf16 v81, v208, v16, 0
    v_dot2_f32_bf16 v81, v209, v17, v81
    v_dot2_f32_bf16 v81, v210, v18, v81
    v_dot2_f32_bf16 v81, v211, v19, v81
    v_add_f32_dpp v82, v80, v80 row_ror:8 row_mask:0xf bank_mask:0xc
    s_nop 1
    v_add_f32_dpp v83, v81, v81 row_ror:8 row_mask:0xf bank_mask:0xc
    v_add_f32_dpp v58, v82, v82 row_half_mirror row_mask:0xf bank_mask:0x5
    s_nop 1
    v_add_f32_dpp v58, v83, v83 row_half_mirror row_mask:0xf bank_mask:0xa
    s_nop 1
    v_add_f32_dpp v58, v58, v58 quad_perm:[1,0,3,2] row_mask:0xf bank_mask:0xf
    s_nop 1
    v_add_f32_dpp v58, v58, v58 quad_perm:[2,3,0,1] row_mask:0xf bank_mask:0xf
    v_mov_b32 v84, v58
    s_nop 1
    v_permlane16_swap_b32 v84, v58
    v_add_f32 v58, v58, v84
    v_dot2_f32_bf16 v78, v212, v16, 0
    v_dot2_f32_bf16 v78, v213, v17, v78
    v_dot2_f32_bf16 v78, v214, v18, v78
    v_dot2_f32_bf16 v78, v215, v19, v78
    v_dot2_f32_bf16 v79, v216, v16, 0
    v_dot2_f32_bf16 v79, v217, v17, v79
    v_dot2_f32_bf16 v79, v218, v18, v79
    v_dot2_f32_bf16 v79, v219, v19, v79
    s_waitcnt vmcnt(4)
    buffer_load_dwordx4 v[148:151], v1, s[40:43], s86 offen offset:3072 nt
    v_dot2_f32_bf16 v80, v220, v16, 0
    v_dot2_f32_bf16 v80, v221, v17, v80
    v_dot2_f32_bf16 v80, v222, v18, v80
    v_dot2_f32_bf16 v80, v223, v19, v80
    v_add_f32_dpp v82, v78, v78 row_ror:8 row_mask:0xf bank_mask:0x3
    v_add_f32_dpp v83, v79, v79 row_ror:8 row_mask:0xf bank_mask:0x3
    v_dot2_f32_bf16 v81, v224, v16, 0
    v_dot2_f32_bf16 v81, v225, v17, v81
    v_dot2_f32_bf16 v81, v226, v18, v81
    v_dot2_f32_bf16 v81, v227, v19, v81
    v_add_f32_dpp v82, v80, v80 row_ror:8 row_mask:0xf bank_mask:0xc
    s_nop 1
    v_add_f32_dpp v83, v81, v81 row_ror:8 row_mask:0xf bank_mask:0xc
    v_add_f32_dpp v59, v82, v82 row_half_mirror row_mask:0xf bank_mask:0x5
    s_nop 1
    v_add_f32_dpp v59, v83, v83 row_half_mirror row_mask:0xf bank_mask:0xa
    s_nop 1
    v_add_f32_dpp v59, v59, v59 quad_perm:[1,0,3,2] row_mask:0xf bank_mask:0xf
    s_nop 1
    v_add_f32_dpp v59, v59, v59 quad_perm:[2,3,0,1] row_mask:0xf bank_mask:0xf
    v_mov_b32 v84, v59
    s_nop 1
    v_permlane16_swap_b32 v84, v59
    v_add_f32 v59, v59, v84
    v_dot2_f32_bf16 v78, v228, v16, 0
    v_dot2_f32_bf16 v78, v229, v17, v78
    v_dot2_f32_bf16 v78, v230, v18, v78
    v_dot2_f32_bf16 v78, v231, v19, v78
    s_waitcnt vmcnt(4)
    s_add_u32 s86, s86, 0x144000
    s_and_b32 s86, s86, 0x3fffff
    buffer_load_dwordx4 v[152:155], v1, s[40:43], s86 offen offset:0 nt
    v_dot2_f32_bf16 v79, v232, v16, 0
    v_dot2_f32_bf16 v79, v233, v17, v79
    v_dot2_f32_bf16 v79, v234, v18, v79
    v_dot2_f32_bf16 v79, v235, v19, v79
    v_dot2_f32_bf16 v80, v236, v16, 0
    v_dot2_f32_bf16 v80, v237, v17, v80
    v_dot2_f32_bf16 v80, v238, v18, v80
    v_dot2_f32_bf16 v80, v239, v19, v80
    v_add_f32_dpp v82, v78, v78 row_ror:8 row_mask:0xf bank_mask:0x3
    v_add_f32_dpp v83, v79, v79 row_ror:8 row_mask:0xf bank_mask:0x3
    v_dot2_f32_bf16 v81, v240, v16, 0
    v_dot2_f32_bf16 v81, v241, v17, v81
    v_dot2_f32_bf16 v81, v242, v18, v81
    v_dot2_f32_bf16 v81, v243, v19, v81
    v_add_f32_dpp v82, v80, v80 row_ror:8 row_mask:0xf bank_mask:0xc
    s_nop 1
    v_add_f32_dpp v83, v81, v81 row_ror:8 row_mask:0xf bank_mask:0xc
    v_add_f32_dpp v60, v82, v82 row_half_mirror row_mask:0xf bank_mask:0x5
    s_nop 1
    v_add_f32_dpp v60, v83, v83 row_half_mirror row_mask:0xf bank_mask:0xa
    s_nop 1
    v_add_f32_dpp v60, v60, v60 quad_perm:[1,0,3,2] row_mask:0xf bank_mask:0xf
    s_nop 1
    v_add_f32_dpp v60, v60, v60 quad_perm:[2,3,0,1] row_mask:0xf bank_mask:0xf
    v_mov_b32 v84, v60
    s_nop 1
    v_permlane16_swap_b32 v84, v60
    v_add_f32 v60, v60, v84
    s_waitcnt vmcnt(4)
    buffer_load_dwordx4 v[156:159], v1, s[40:43], s86 offen offset:1024 nt
    v_dot2_f32_bf16 v78, v244, v16, 0
    v_dot2_f32_bf16 v78, v245, v17, v78
    v_dot2_f32_bf16 v78, v246, v18, v78
    v_dot2_f32_bf16 v78, v247, v19, v78
    v_dot2_f32_bf16 v79, v248, v16, 0
    v_dot2_f32_bf16 v79, v249, v17, v79
    v_dot2_f32_bf16 v79, v250, v18, v79
    v_dot2_f32_bf16 v79, v251, v19, v79
    v_dot2_f32_bf16 v80, v252, v16, 0
    v_dot2_f32_bf16 v80, v253, v17, v80
    v_dot2_f32_bf16 v80, v254, v18, v80
    v_dot2_f32_bf16 v80, v255, v19, v80
    v_add_f32_dpp v82, v78, v78 row_ror:8 row_mask:0xf bank_mask:0x3
    v_add_f32_dpp v83, v79, v79 row_ror:8 row_mask:0xf bank_mask:0x3
    s_waitcnt vmcnt(4)
    buffer_load_dwordx4 v[160:163], v1, s[40:43], s86 offen offset:2048 nt
    v_dot2_f32_bf16 v81, v100, v16, 0
    v_dot2_f32_bf16 v81, v101, v17, v81
    v_dot2_f32_bf16 v81, v102, v18, v81
    v_dot2_f32_bf16 v81, v103, v19, v81
    v_add_f32_dpp v82, v80, v80 row_ror:8 row_mask:0xf bank_mask:0xc
    s_nop 1
    v_add_f32_dpp v83, v81, v81 row_ror:8 row_mask:0xf bank_mask:0xc
    v_add_f32_dpp v61, v82, v82 row_half_mirror row_mask:0xf bank_mask:0x5
    s_nop 1
    v_add_f32_dpp v61, v83, v83 row_half_mirror row_mask:0xf bank_mask:0xa
    s_nop 1
    v_add_f32_dpp v61, v61, v61 quad_perm:[1,0,3,2] row_mask:0xf bank_mask:0xf
    s_nop 1
    v_add_f32_dpp v61, v61, v61 quad_perm:[2,3,0,1] row_mask:0xf bank_mask:0xf
    v_mov_b32 v84, v61
    s_nop 1
    v_permlane16_swap_b32 v84, v61
    v_add_f32 v61, v61, v84
    v_dot2_f32_bf16 v78, v104, v16, 0
    v_dot2_f32_bf16 v78, v105, v17, v78
    v_dot2_f32_bf16 v78, v106, v18, v78
    v_dot2_f32_bf16 v78, v107, v19, v78
    v_dot2_f32_bf16 v79, v108, v16, 0
    v_dot2_f32_bf16 v79, v109, v17, v79
    v_dot2_f32_bf16 v79, v110, v18, v79
    v_dot2_f32_bf16 v79, v111, v19, v79
    s_waitcnt vmcnt(4)
    buffer_load_dwordx4 v[164:167], v1, s[40:43], s86 offen offset:3072 nt
    v_dot2_f32_bf16 v80, v112, v16, 0
    v_dot2_f32_bf16 v80, v113, v17, v80
    v_dot2_f32_bf16 v80, v114, v18, v80
    v_dot2_f32_bf16 v80, v115, v19, v80
    v_add_f32_dpp v82, v78, v78 row_ror:8 row_mask:0xf bank_mask:0x3
    v_add_f32_dpp v83, v79, v79 row_ror:8 row_mask:0xf bank_mask:0x3
    v_dot2_f32_bf16 v81, v116, v16, 0
    v_dot2_f32_bf16 v81, v117, v17, v81
    v_dot2_f32_bf16 v81, v118, v18, v81
    v_dot2_f32_bf16 v81, v119, v19, v81
    v_add_f32_dpp v82, v80, v80 row_ror:8 row_mask:0xf bank_mask:0xc
    s_nop 1
    v_add_f32_dpp v83, v81, v81 row_ror:8 row_mask:0xf bank_mask:0xc
    v_add_f32_dpp v62, v82, v82 row_half_mirror row_mask:0xf bank_mask:0x5
    s_nop 1
    v_add_f32_dpp v62, v83, v83 row_half_mirror row_mask:0xf bank_mask:0xa
    s_nop 1
    v_add_f32_dpp v62, v62, v62 quad_perm:[1,0,3,2] row_mask:0xf bank_mask:0xf
    s_nop 1
    v_add_f32_dpp v62, v62, v62 quad_perm:[2,3,0,1] row_mask:0xf bank_mask:0xf
    v_mov_b32 v84, v62
    s_nop 1
    v_permlane16_swap_b32 v84, v62
    v_add_f32 v62, v62, v84
    v_dot2_f32_bf16 v78, v120, v16, 0
    v_dot2_f32_bf16 v78, v121, v17, v78
    v_dot2_f32_bf16 v78, v122, v18, v78
    v_dot2_f32_bf16 v78, v123, v19, v78
    s_waitcnt vmcnt(4)
    s_add_u32 s86, s86, 0x144000
    s_and_b32 s86, s86, 0x3fffff
    buffer_load_dwordx4 v[168:171], v1, s[40:43], s86 offen offset:0 nt
    v_dot2_f32_bf16 v79, v124, v16, 0
    v_dot2_f32_bf16 v79, v125, v17, v79
    v_dot2_f32_bf16 v79, v126, v18, v79
    v_dot2_f32_bf16 v79, v127, v19, v79
    v_dot2_f32_bf16 v80, v128, v16, 0
    v_dot2_f32_bf16 v80, v129, v17, v80
    v_dot2_f32_bf16 v80, v130, v18, v80
    v_dot2_f32_bf16 v80, v131, v19, v80
    v_add_f32_dpp v82, v78, v78 row_ror:8 row_mask:0xf bank_mask:0x3
    v_add_f32_dpp v83, v79, v79 row_ror:8 row_mask:0xf bank_mask:0x3
    v_dot2_f32_bf16 v81, v132, v16, 0
    v_dot2_f32_bf16 v81, v133, v17, v81
    v_dot2_f32_bf16 v81, v134, v18, v81
    v_dot2_f32_bf16 v81, v135, v19, v81
    v_add_f32_dpp v82, v80, v80 row_ror:8 row_mask:0xf bank_mask:0xc
    s_nop 1
    v_add_f32_dpp v83, v81, v81 row_ror:8 row_mask:0xf bank_mask:0xc
    v_add_f32_dpp v63, v82, v82 row_half_mirror row_mask:0xf bank_mask:0x5
    s_nop 1
    v_add_f32_dpp v63, v83, v83 row_half_mirror row_mask:0xf bank_mask:0xa
    s_nop 1
    v_add_f32_dpp v63, v63, v63 quad_perm:[1,0,3,2] row_mask:0xf bank_mask:0xf
    s_nop 1
    v_add_f32_dpp v63, v63, v63 quad_perm:[2,3,0,1] row_mask:0xf bank_mask:0xf
    v_mov_b32 v84, v63
    s_nop 1
    v_permlane16_swap_b32 v84, v63
    v_add_f32 v63, v63, v84
    s_waitcnt vmcnt(4)
    buffer_load_dwordx4 v[172:175], v1, s[40:43], s86 offen offset:1024 nt
    v_dot2_f32_bf16 v78, v136, v16, 0
    v_dot2_f32_bf16 v78, v137, v17, v78
    v_dot2_f32_bf16 v78, v138, v18, v78
    v_dot2_f32_bf16 v78, v139, v19, v78
    v_dot2_f32_bf16 v79, v140, v16, 0
    v_dot2_f32_bf16 v79, v141, v17, v79
    v_dot2_f32_bf16 v79, v142, v18, v79
    v_dot2_f32_bf16 v79, v143, v19, v79
    v_dot2_f32_bf16 v80, v144, v16, 0
    v_dot2_f32_bf16 v80, v145, v17, v80
    v_dot2_f32_bf16 v80, v146, v18, v80
    v_dot2_f32_bf16 v80, v147, v19, v80
    v_add_f32_dpp v82, v78, v78 row_ror:8 row_mask:0xf bank_mask:0x3
    v_add_f32_dpp v83, v79, v79 row_ror:8 row_mask:0xf bank_mask:0x3
    s_waitcnt vmcnt(4)
    buffer_load_dwordx4 v[176:179], v1, s[40:43], s86 offen offset:2048 nt
    v_dot2_f32_bf16 v81, v148, v16, 0
    v_dot2_f32_bf16 v81, v149, v17, v81
    v_dot2_f32_bf16 v81, v150, v18, v81
    v_dot2_f32_bf16 v81, v151, v19, v81
    v_add_f32_dpp v82, v80, v80 row_ror:8 row_mask:0xf bank_mask:0xc
    s_nop 1
    v_add_f32_dpp v83, v81, v81 row_ror:8 row_mask:0xf bank_mask:0xc
    v_add_f32_dpp v64, v82, v82 row_half_mirror row_mask:0xf bank_mask:0x5
    s_nop 1
    v_add_f32_dpp v64, v83, v83 row_half_mirror row_mask:0xf bank_mask:0xa
    s_nop 1
    v_add_f32_dpp v64, v64, v64 quad_perm:[1,0,3,2] row_mask:0xf bank_mask:0xf
    s_nop 1
    v_add_f32_dpp v64, v64, v64 quad_perm:[2,3,0,1] row_mask:0xf bank_mask:0xf
    v_mov_b32 v84, v64
    s_nop 1
    v_permlane16_swap_b32 v84, v64
    v_add_f32 v64, v64, v84
    v_dot2_f32_bf16 v78, v152, v16, 0
    v_dot2_f32_bf16 v78, v153, v17, v78
    v_dot2_f32_bf16 v78, v154, v18, v78
    v_dot2_f32_bf16 v78, v155, v19, v78
    v_dot2_f32_bf16 v79, v156, v16, 0
    v_dot2_f32_bf16 v79, v157, v17, v79
    v_dot2_f32_bf16 v79, v158, v18, v79
    v_dot2_f32_bf16 v79, v159, v19, v79
    s_waitcnt vmcnt(4)
    buffer_load_dwordx4 v[180:183], v1, s[40:43], s86 offen offset:3072 nt
    v_dot2_f32_bf16 v80, v160, v16, 0
    v_dot2_f32_bf16 v80, v161, v17, v80
    v_dot2_f32_bf16 v80, v162, v18, v80
    v_dot2_f32_bf16 v80, v163, v19, v80
    v_add_f32_dpp v82, v78, v78 row_ror:8 row_mask:0xf bank_mask:0x3
    v_add_f32_dpp v83, v79, v79 row_ror:8 row_mask:0xf bank_mask:0x3
    s_waitcnt vmcnt(4)
    s_add_u32 s86, s86, 0x144000
    s_and_b32 s86, s86, 0x3fffff
    buffer_load_dwordx4 v[184:187], v1, s[40:43], s86 offen offset:0 nt
    v_dot2_f32_bf16 v81, v164, v16, 0
    v_dot2_f32_bf16 v81, v165, v17, v81
    v_dot2_f32_bf16 v81, v166, v18, v81
    v_dot2_f32_bf16 v81, v167, v19, v81
    v_add_f32_dpp v82, v80, v80 row_ror:8 row_mask:0xf bank_mask:0xc
    s_nop 1
    v_add_f32_dpp v83, v81, v81 row_ror:8 row_mask:0xf bank_mask:0xc
    v_add_f32_dpp v65, v82, v82 row_half_mirror row_mask:0xf bank_mask:0x5
    s_nop 1
    v_add_f32_dpp v65, v83, v83 row_half_mirror row_mask:0xf bank_mask:0xa
    s_nop 1
    v_add_f32_dpp v65, v65, v65 quad_perm:[1,0,3,2] row_mask:0xf bank_mask:0xf
    s_nop 1
    v_add_f32_dpp v65, v65, v65 quad_perm:[2,3,0,1] row_mask:0xf bank_mask:0xf
    v_mov_b32 v84, v65
    s_nop 1
    v_permlane16_swap_b32 v84, v65
    v_add_f32 v65, v65, v84
    s_waitcnt vmcnt(4)
    buffer_load_dwordx4 v[188:191], v1, s[40:43], s86 offen offset:1024 nt
    v_dot2_f32_bf16 v78, v168, v16, 0
    v_dot2_f32_bf16 v78, v169, v17, v78
    v_dot2_f32_bf16 v78, v170, v18, v78
    v_dot2_f32_bf16 v78, v171, v19, v78
    s_waitcnt vmcnt(4)
    buffer_load_dwordx4 v[192:195], v1, s[40:43], s86 offen offset:2048 nt
    v_dot2_f32_bf16 v79, v172, v16, 0
    v_dot2_f32_bf16 v79, v173, v17, v79
    v_dot2_f32_bf16 v79, v174, v18, v79
    v_dot2_f32_bf16 v79, v175, v19, v79
    s_waitcnt vmcnt(4)
    buffer_load_dwordx4 v[196:199], v1, s[40:43], s86 offen offset:3072 nt
    v_dot2_f32_bf16 v80, v176, v16, 0
    v_dot2_f32_bf16 v80, v177, v17, v80
    v_dot2_f32_bf16 v80, v178, v18, v80
    v_dot2_f32_bf16 v80, v179, v19, v80
    v_add_f32_dpp v82, v78, v78 row_ror:8 row_mask:0xf bank_mask:0x3
    v_add_f32_dpp v83, v79, v79 row_ror:8 row_mask:0xf bank_mask:0x3
    s_waitcnt vmcnt(4)
    buffer_load_dwordx4 v[200:203], v1, s[32:35], 0 offen offset:0 nt
    v_dot2_f32_bf16 v81, v180, v16, 0
    v_dot2_f32_bf16 v81, v181, v17, v81
    v_dot2_f32_bf16 v81, v182, v18, v81
    v_dot2_f32_bf16 v81, v183, v19, v81
    v_add_f32_dpp v82, v80, v80 row_ror:8 row_mask:0xf bank_mask:0xc
    s_nop 1
    v_add_f32_dpp v83, v81, v81 row_ror:8 row_mask:0xf bank_mask:0xc
    v_add_f32_dpp v66, v82, v82 row_half_mirror row_mask:0xf bank_mask:0x5
    s_nop 1
    v_add_f32_dpp v66, v83, v83 row_half_mirror row_mask:0xf bank_mask:0xa
    s_nop 1
    v_add_f32_dpp v66, v66, v66 quad_perm:[1,0,3,2] row_mask:0xf bank_mask:0xf
    s_nop 1
    v_add_f32_dpp v66, v66, v66 quad_perm:[2,3,0,1] row_mask:0xf bank_mask:0xf
    v_mov_b32 v84, v66
    s_nop 1
    v_permlane16_swap_b32 v84, v66
    v_add_f32 v66, v66, v84
    s_waitcnt vmcnt(4)
    buffer_load_dwordx4 v[204:207], v1, s[32:35], 0 offen offset:1024 nt
    v_dot2_f32_bf16 v78, v184, v16, 0
    v_dot2_f32_bf16 v78, v185, v17, v78
    v_dot2_f32_bf16 v78, v186, v18, v78
    v_dot2_f32_bf16 v78, v187, v19, v78
    s_waitcnt vmcnt(4)
    buffer_load_dwordx4 v[208:211], v1, s[32:35], 0 offen offset:2048 nt
    v_dot2_f32_bf16 v79, v188, v16, 0
    v_dot2_f32_bf16 v79, v189, v17, v79
    v_dot2_f32_bf16 v79, v190, v18, v79
    v_dot2_f32_bf16 v79, v191, v19, v79
    s_waitcnt vmcnt(4)
    buffer_load_dwordx4 v[212:215], v1, s[32:35], 0 offen offset:3072 nt
    v_dot2_f32_bf16 v80, v192, v16, 0
    v_dot2_f32_bf16 v80, v193, v17, v80
    v_dot2_f32_bf16 v80, v194, v18, v80
    v_dot2_f32_bf16 v80, v195, v19, v80
    v_add_f32_dpp v82, v78, v78 row_ror:8 row_mask:0xf bank_mask:0x3
    v_add_f32_dpp v83, v79, v79 row_ror:8 row_mask:0xf bank_mask:0x3
    s_waitcnt vmcnt(4)
    buffer_load_dwordx4 v[216:219], v1, s[32:35], s27 offen offset:0 nt
    v_dot2_f32_bf16 v81, v196, v16, 0
    v_dot2_f32_bf16 v81, v197, v17, v81
    v_dot2_f32_bf16 v81, v198, v18, v81
    v_dot2_f32_bf16 v81, v199, v19, v81
    v_add_f32_dpp v82, v80, v80 row_ror:8 row_mask:0xf bank_mask:0xc
    s_nop 1
    v_add_f32_dpp v83, v81, v81 row_ror:8 row_mask:0xf bank_mask:0xc
    v_add_f32_dpp v67, v82, v82 row_half_mirror row_mask:0xf bank_mask:0x5
    s_nop 1
    v_add_f32_dpp v67, v83, v83 row_half_mirror row_mask:0xf bank_mask:0xa
    s_nop 1
    v_add_f32_dpp v67, v67, v67 quad_perm:[1,0,3,2] row_mask:0xf bank_mask:0xf
    s_nop 1
    v_add_f32_dpp v67, v67, v67 quad_perm:[2,3,0,1] row_mask:0xf bank_mask:0xf
    v_mov_b32 v84, v67
    s_nop 1
    v_permlane16_swap_b32 v84, v67
    v_add_f32 v67, v67, v84
    s_waitcnt vmcnt(4)
    buffer_load_dwordx4 v[220:223], v1, s[32:35], s27 offen offset:1024 nt
    v_dot2_f32_bf16 v78, v200, v20, 0
    v_dot2_f32_bf16 v85, v200, v24, 0
    v_dot2_f32_bf16 v78, v201, v21, v78
    v_dot2_f32_bf16 v85, v201, v25, v85
    v_dot2_f32_bf16 v78, v202, v22, v78
    v_dot2_f32_bf16 v85, v202, v26, v85
    v_dot2_f32_bf16 v78, v203, v23, v78
    v_dot2_f32_bf16 v85, v203, v27, v85
    s_waitcnt vmcnt(4)
    buffer_load_dwordx4 v[224:227], v1, s[32:35], s27 offen offset:2048 nt
    v_dot2_f32_bf16 v79, v204, v20, 0
    v_dot2_f32_bf16 v86, v204, v24, 0
    v_dot2_f32_bf16 v79, v205, v21, v79
    v_dot2_f32_bf16 v86, v205, v25, v86
    v_dot2_f32_bf16 v79, v206, v22, v79
    v_dot2_f32_bf16 v86, v206, v26, v86
    v_dot2_f32_bf16 v79, v207, v23, v79
    v_dot2_f32_bf16 v86, v207, v27, v86
    s_mov_b32 s77, 0x1111
    s_mov_b32 exec_lo, s77
    s_mov_b32 exec_hi, s77
    ds_write_b128 v96, v[52:55] offset:0
    ds_write_b128 v96, v[56:59] offset:16
    ds_write_b128 v96, v[60:63] offset:32
    ds_write_b128 v96, v[64:67] offset:48
    s_mov_b64 exec, -1
    s_waitcnt vmcnt(4)
    buffer_load_dwordx4 v[228:231], v1, s[32:35], s27 offen offset:3072 nt
    v_dot2_f32_bf16 v80, v208, v20, 0
    v_dot2_f32_bf16 v87, v208, v24, 0
    v_dot2_f32_bf16 v80, v209, v21, v80
    v_dot2_f32_bf16 v87, v209, v25, v87
    v_dot2_f32_bf16 v80, v210, v22, v80
    v_dot2_f32_bf16 v87, v210, v26, v87
    v_dot2_f32_bf16 v80, v211, v23, v80
    v_dot2_f32_bf16 v87, v211, v27, v87
    v_add_f32_dpp v82, v78, v78 row_ror:8 row_mask:0xf bank_mask:0x3
    v_add_f32_dpp v83, v79, v79 row_ror:8 row_mask:0xf bank_mask:0x3
    v_add_f32_dpp v89, v85, v85 row_ror:8 row_mask:0xf bank_mask:0x3
    v_add_f32_dpp v90, v86, v86 row_ror:8 row_mask:0xf bank_mask:0x3
    s_waitcnt vmcnt(4)
    buffer_load_dwordx4 v[232:235], v6, s[36:39], 0 offen nt
    v_dot2_f32_bf16 v81, v212, v20, 0
    v_dot2_f32_bf16 v88, v212, v24, 0
    v_dot2_f32_bf16 v81, v213, v21, v81
    v_dot2_f32_bf16 v88, v213, v25, v88
    v_dot2_f32_bf16 v81, v214, v22, v81
    v_dot2_f32_bf16 v88, v214, v26, v88
    v_dot2_f32_bf16 v81, v215, v23, v81
    v_dot2_f32_bf16 v88, v215, v27, v88
    v_add_f32_dpp v82, v80, v80 row_ror:8 row_mask:0xf bank_mask:0xc
    v_add_f32_dpp v89, v87, v87 row_ror:8 row_mask:0xf bank_mask:0xc
    v_add_f32_dpp v83, v81, v81 row_ror:8 row_mask:0xf bank_mask:0xc
    v_add_f32_dpp v90, v88, v88 row_ror:8 row_mask:0xf bank_mask:0xc
    v_add_f32_dpp v68, v82, v82 row_half_mirror row_mask:0xf bank_mask:0x5
    v_add_f32_dpp v70, v89, v89 row_half_mirror row_mask:0xf bank_mask:0x5
    s_nop 0
    v_add_f32_dpp v68, v83, v83 row_half_mirror row_mask:0xf bank_mask:0xa
    v_add_f32_dpp v70, v90, v90 row_half_mirror row_mask:0xf bank_mask:0xa
    s_nop 0
    v_add_f32_dpp v68, v68, v68 quad_perm:[1,0,3,2] row_mask:0xf bank_mask:0xf
    v_add_f32_dpp v70, v70, v70 quad_perm:[1,0,3,2] row_mask:0xf bank_mask:0xf
    s_nop 0
    v_add_f32_dpp v68, v68, v68 quad_perm:[2,3,0,1] row_mask:0xf bank_mask:0xf
    v_add_f32_dpp v70, v70, v70 quad_perm:[2,3,0,1] row_mask:0xf bank_mask:0xf
    v_mov_b32 v84, v68
    v_mov_b32 v91, v70
    s_nop 0
    v_permlane16_swap_b32 v84, v68
    v_permlane16_swap_b32 v91, v70
    v_add_f32 v68, v68, v84
    v_add_f32 v70, v70, v91
    s_waitcnt vmcnt(4)
    buffer_load_dwordx4 v[236:239], v7, s[36:39], 0 offen nt
    v_dot2_f32_bf16 v78, v216, v20, 0
    v_dot2_f32_bf16 v85, v216, v24, 0
    v_dot2_f32_bf16 v78, v217, v21, v78
    v_dot2_f32_bf16 v85, v217, v25, v85
    v_dot2_f32_bf16 v78, v218, v22, v78
    v_dot2_f32_bf16 v85, v218, v26, v85
    v_dot2_f32_bf16 v78, v219, v23, v78
    v_dot2_f32_bf16 v85, v219, v27, v85
    s_waitcnt vmcnt(4)
    buffer_load_dwordx4 v[240:243], v8, s[36:39], 0 offen nt
    v_dot2_f32_bf16 v79, v220, v20, 0
    v_dot2_f32_bf16 v86, v220, v24, 0
    v_dot2_f32_bf16 v79, v221, v21, v79
    v_dot2_f32_bf16 v86, v221, v25, v86
    v_dot2_f32_bf16 v79, v222, v22, v79
    v_dot2_f32_bf16 v86, v222, v26, v86
    v_dot2_f32_bf16 v79, v223, v23, v79
    v_dot2_f32_bf16 v86, v223, v27, v86
    s_waitcnt vmcnt(4)
    buffer_load_dwordx4 v[244:247], v9, s[36:39], 0 offen nt
    v_dot2_f32_bf16 v80, v224, v20, 0
    v_dot2_f32_bf16 v87, v224, v24, 0
    v_dot2_f32_bf16 v80, v225, v21, v80
    v_dot2_f32_bf16 v87, v225, v25, v87
    v_dot2_f32_bf16 v80, v226, v22, v80
    v_dot2_f32_bf16 v87, v226, v26, v87
    v_dot2_f32_bf16 v80, v227, v23, v80
    v_dot2_f32_bf16 v87, v227, v27, v87
    v_add_f32_dpp v82, v78, v78 row_ror:8 row_mask:0xf bank_mask:0x3
    v_add_f32_dpp v83, v79, v79 row_ror:8 row_mask:0xf bank_mask:0x3
    v_add_f32_dpp v89, v85, v85 row_ror:8 row_mask:0xf bank_mask:0x3
    v_add_f32_dpp v90, v86, v86 row_ror:8 row_mask:0xf bank_mask:0x3
    s_waitcnt vmcnt(4)
    buffer_load_dwordx4 v[248:251], v6, s[36:39], s27 offen nt
    v_dot2_f32_bf16 v81, v228, v20, 0
    v_dot2_f32_bf16 v88, v228, v24, 0
    v_dot2_f32_bf16 v81, v229, v21, v81
    v_dot2_f32_bf16 v88, v229, v25, v88
    v_dot2_f32_bf16 v81, v230, v22, v81
    v_dot2_f32_bf16 v88, v230, v26, v88
    v_dot2_f32_bf16 v81, v231, v23, v81
    v_dot2_f32_bf16 v88, v231, v27, v88
    v_add_f32_dpp v82, v80, v80 row_ror:8 row_mask:0xf bank_mask:0xc
    v_add_f32_dpp v89, v87, v87 row_ror:8 row_mask:0xf bank_mask:0xc
    v_add_f32_dpp v83, v81, v81 row_ror:8 row_mask:0xf bank_mask:0xc
    v_add_f32_dpp v90, v88, v88 row_ror:8 row_mask:0xf bank_mask:0xc
    v_add_f32_dpp v69, v82, v82 row_half_mirror row_mask:0xf bank_mask:0x5
    v_add_f32_dpp v71, v89, v89 row_half_mirror row_mask:0xf bank_mask:0x5
    s_nop 0
    v_add_f32_dpp v69, v83, v83 row_half_mirror row_mask:0xf bank_mask:0xa
    v_add_f32_dpp v71, v90, v90 row_half_mirror row_mask:0xf bank_mask:0xa
    s_nop 0
    v_add_f32_dpp v69, v69, v69 quad_perm:[1,0,3,2] row_mask:0xf bank_mask:0xf
    v_add_f32_dpp v71, v71, v71 quad_perm:[1,0,3,2] row_mask:0xf bank_mask:0xf
    s_nop 0
    v_add_f32_dpp v69, v69, v69 quad_perm:[2,3,0,1] row_mask:0xf bank_mask:0xf
    v_add_f32_dpp v71, v71, v71 quad_perm:[2,3,0,1] row_mask:0xf bank_mask:0xf
    v_mov_b32 v84, v69
    v_mov_b32 v91, v71
    s_nop 0
    v_permlane16_swap_b32 v84, v69
    v_permlane16_swap_b32 v91, v71
    v_add_f32 v69, v69, v84
    v_add_f32 v71, v71, v91
    s_waitcnt vmcnt(4)
    buffer_load_dwordx4 v[252:255], v7, s[36:39], s27 offen nt
    s_mov_b32 exec_lo, s77
    s_mov_b32 exec_hi, s77
    ds_write_b128 v96, v[68:71] offset:64
    s_mov_b64 exec, -1
    buffer_load_dwordx4 v[100:103], v8, s[36:39], s27 offen nt
    buffer_load_dwordx4 v[104:107], v9, s[36:39], s27 offen nt
    buffer_load_dwordx4 v[108:111], v6, s[44:47], s26 offen nt
    s_waitcnt lgkmcnt(0)
    s_barrier
    ds_read_b128 v[68:71], v97 offset:64
    ds_read_b128 v[52:55], v97 offset:0
    ds_read_b128 v[56:59], v97 offset:16
    ds_read_b128 v[60:63], v97 offset:32
    ds_read_b128 v[64:67], v97 offset:48
    ds_read_b32 v3, v95 offset:2564
    s_waitcnt lgkmcnt(0)
    v_readfirstlane_b32 s1, v3
    v_max_f32 v73, v68, v69
    v_max_f32 v74, v70, v71
    v_max3_f32 v72, v52, v53, v54
    v_max3_f32 v2, v55, v56, v57
    v_max3_f32 v72, v72, v58, v59
    v_max3_f32 v2, v2, v60, v61
    v_max3_f32 v72, v72, v62, v63
    v_max3_f32 v2, v2, v64, v65
    v_max3_f32 v72, v72, v66, v67
    v_max_f32 v72, v72, v2
    v_max_f32_dpp v73, v73, v73 quad_perm:[1,0,3,2] row_mask:0xf bank_mask:0xf
    v_max_f32_dpp v74, v74, v74 quad_perm:[1,0,3,2] row_mask:0xf bank_mask:0xf
    v_max_f32_dpp v72, v72, v72 quad_perm:[1,0,3,2] row_mask:0xf bank_mask:0xf
    v_max_f32_dpp v73, v73, v73 quad_perm:[2,3,0,1] row_mask:0xf bank_mask:0xf
    v_max_f32_dpp v74, v74, v74 quad_perm:[2,3,0,1] row_mask:0xf bank_mask:0xf
    v_max_f32_dpp v72, v72, v72 quad_perm:[2,3,0,1] row_mask:0xf bank_mask:0xf
    v_max_f32_dpp v73, v73, v73 row_ror:8 row_mask:0xf bank_mask:0xf
    v_max_f32_dpp v74, v74, v74 row_ror:8 row_mask:0xf bank_mask:0xf
    v_max_f32_dpp v72, v72, v72 row_ror:8 row_mask:0xf bank_mask:0xf
    v_mov_b32 v78, v73
    v_mov_b32 v79, v74
    v_mov_b32 v80, v72
    v_permlane16_swap_b32 v78, v73
    v_permlane16_swap_b32 v79, v74
    v_permlane16_swap_b32 v80, v72
    v_max_f32 v73, v73, v78
    v_max_f32 v74, v74, v79
    v_max_f32 v72, v72, v80
    v_mov_b32 v78, v73
    v_mov_b32 v79, v74
    v_mov_b32 v80, v72
    v_permlane32_swap_b32 v78, v73
    v_permlane32_swap_b32 v79, v74
    v_permlane32_swap_b32 v80, v72
    v_max_f32 v73, v73, v78
    v_max_f32 v74, v74, v79
    v_max_f32 v72, v72, v80
    v_mul_f32_e64 v73, s90, -v73
    v_mul_f32_e64 v74, s90, -v74
    v_mul_f32_e64 v72, s90, -v72
    v_fma_f32 v68, v68, s90, v73
    v_fma_f32 v70, v70, s90, v74
    v_exp_f32 v68, v68
    v_exp_f32 v70, v70
    v_cvt_pk_bf16_f32 v68, v68, 0
    v_cvt_pk_bf16_f32 v70, v70, 0
    v_lshlrev_b32 v92, 16, v68
    v_lshlrev_b32 v93, 16, v70
    v_dot2c_f32_bf16_dpp v36, v68, v232 quad_perm:[0,0,0,0] row_mask:0xf bank_mask:0xf
    v_dot2c_f32_bf16_dpp v38, v68, v233 quad_perm:[0,0,0,0] row_mask:0xf bank_mask:0xf
    v_dot2c_f32_bf16_dpp v40, v68, v234 quad_perm:[0,0,0,0] row_mask:0xf bank_mask:0xf
    v_dot2c_f32_bf16_dpp v42, v68, v235 quad_perm:[0,0,0,0] row_mask:0xf bank_mask:0xf
    v_dot2c_f32_bf16_dpp v37, v92, v232 quad_perm:[0,0,0,0] row_mask:0xf bank_mask:0xf
    v_dot2c_f32_bf16_dpp v39, v92, v233 quad_perm:[0,0,0,0] row_mask:0xf bank_mask:0xf
    v_dot2c_f32_bf16_dpp v41, v92, v234 quad_perm:[0,0,0,0] row_mask:0xf bank_mask:0xf
    v_dot2c_f32_bf16_dpp v43, v92, v235 quad_perm:[0,0,0,0] row_mask:0xf bank_mask:0xf
    v_dot2c_f32_bf16_dpp v44, v70, v232 quad_perm:[0,0,0,0] row_mask:0xf bank_mask:0xf
    v_dot2c_f32_bf16_dpp v46, v70, v233 quad_perm:[0,0,0,0] row_mask:0xf bank_mask:0xf
    v_dot2c_f32_bf16_dpp v48, v70, v234 quad_perm:[0,0,0,0] row_mask:0xf bank_mask:0xf
    v_dot2c_f32_bf16_dpp v50, v70, v235 quad_perm:[0,0,0,0] row_mask:0xf bank_mask:0xf
    v_dot2c_f32_bf16_dpp v45, v93, v232 quad_perm:[0,0,0,0] row_mask:0xf bank_mask:0xf
    v_dot2c_f32_bf16_dpp v47, v93, v233 quad_perm:[0,0,0,0] row_mask:0xf bank_mask:0xf
    v_dot2c_f32_bf16_dpp v49, v93, v234 quad_perm:[0,0,0,0] row_mask:0xf bank_mask:0xf
    v_dot2c_f32_bf16_dpp v51, v93, v235 quad_perm:[0,0,0,0] row_mask:0xf bank_mask:0xf
    s_waitcnt vmcnt(7)
    v_dot2c_f32_bf16_dpp v36, v68, v236 quad_perm:[1,1,1,1] row_mask:0xf bank_mask:0xf
    v_dot2c_f32_bf16_dpp v38, v68, v237 quad_perm:[1,1,1,1] row_mask:0xf bank_mask:0xf
    v_dot2c_f32_bf16_dpp v40, v68, v238 quad_perm:[1,1,1,1] row_mask:0xf bank_mask:0xf
    v_dot2c_f32_bf16_dpp v42, v68, v239 quad_perm:[1,1,1,1] row_mask:0xf bank_mask:0xf
    v_dot2c_f32_bf16_dpp v37, v92, v236 quad_perm:[1,1,1,1] row_mask:0xf bank_mask:0xf
    v_dot2c_f32_bf16_dpp v39, v92, v237 quad_perm:[1,1,1,1] row_mask:0xf bank_mask:0xf
    v_dot2c_f32_bf16_dpp v41, v92, v238 quad_perm:[1,1,1,1] row_mask:0xf bank_mask:0xf
    v_dot2c_f32_bf16_dpp v43, v92, v239 quad_perm:[1,1,1,1] row_mask:0xf bank_mask:0xf
    v_dot2c_f32_bf16_dpp v44, v70, v236 quad_perm:[1,1,1,1] row_mask:0xf bank_mask:0xf
    v_dot2c_f32_bf16_dpp v46, v70, v237 quad_perm:[1,1,1,1] row_mask:0xf bank_mask:0xf
    v_dot2c_f32_bf16_dpp v48, v70, v238 quad_perm:[1,1,1,1] row_mask:0xf bank_mask:0xf
    v_dot2c_f32_bf16_dpp v50, v70, v239 quad_perm:[1,1,1,1] row_mask:0xf bank_mask:0xf
    v_dot2c_f32_bf16_dpp v45, v93, v236 quad_perm:[1,1,1,1] row_mask:0xf bank_mask:0xf
    v_dot2c_f32_bf16_dpp v47, v93, v237 quad_perm:[1,1,1,1] row_mask:0xf bank_mask:0xf
    v_dot2c_f32_bf16_dpp v49, v93, v238 quad_perm:[1,1,1,1] row_mask:0xf bank_mask:0xf
    v_dot2c_f32_bf16_dpp v51, v93, v239 quad_perm:[1,1,1,1] row_mask:0xf bank_mask:0xf
    v_fma_f32 v69, v69, s90, v73
    v_fma_f32 v71, v71, s90, v74
    v_exp_f32 v69, v69
    v_exp_f32 v71, v71
    v_cvt_pk_bf16_f32 v69, v69, 0
    v_cvt_pk_bf16_f32 v71, v71, 0
    s_waitcnt vmcnt(6)
    v_dot2c_f32_bf16_dpp v36, v68, v240 quad_perm:[2,2,2,2] row_mask:0xf bank_mask:0xf
    v_dot2c_f32_bf16_dpp v38, v68, v241 quad_perm:[2,2,2,2] row_mask:0xf bank_mask:0xf
    v_dot2c_f32_bf16_dpp v40, v68, v242 quad_perm:[2,2,2,2] row_mask:0xf bank_mask:0xf
    v_dot2c_f32_bf16_dpp v42, v68, v243 quad_perm:[2,2,2,2] row_mask:0xf bank_mask:0xf
    v_dot2c_f32_bf16_dpp v37, v92, v240 quad_perm:[2,2,2,2] row_mask:0xf bank_mask:0xf
    v_dot2c_f32_bf16_dpp v39, v92, v241 quad_perm:[2,2,2,2] row_mask:0xf bank_mask:0xf
    v_dot2c_f32_bf16_dpp v41, v92, v242 quad_perm:[2,2,2,2] row_mask:0xf bank_mask:0xf
    v_dot2c_f32_bf16_dpp v43, v92, v243 quad_perm:[2,2,2,2] row_mask:0xf bank_mask:0xf
    v_dot2c_f32_bf16_dpp v44, v70, v240 quad_perm:[2,2,2,2] row_mask:0xf bank_mask:0xf
    v_dot2c_f32_bf16_dpp v46, v70, v241 quad_perm:[2,2,2,2] row_mask:0xf bank_mask:0xf
    v_dot2c_f32_bf16_dpp v48, v70, v242 quad_perm:[2,2,2,2] row_mask:0xf bank_mask:0xf
    v_dot2c_f32_bf16_dpp v50, v70, v243 quad_perm:[2,2,2,2] row_mask:0xf bank_mask:0xf
    v_dot2c_f32_bf16_dpp v45, v93, v240 quad_perm:[2,2,2,2] row_mask:0xf bank_mask:0xf
    v_dot2c_f32_bf16_dpp v47, v93, v241 quad_perm:[2,2,2,2] row_mask:0xf bank_mask:0xf
    v_dot2c_f32_bf16_dpp v49, v93, v242 quad_perm:[2,2,2,2] row_mask:0xf bank_mask:0xf
    v_dot2c_f32_bf16_dpp v51, v93, v243 quad_perm:[2,2,2,2] row_mask:0xf bank_mask:0xf
    s_waitcnt vmcnt(4)
    buffer_load_dwordx4 v[112:115], v7, s[44:47], s26 offen nt
    v_dot2c_f32_bf16_dpp v36, v68, v244 quad_perm:[3,3,3,3] row_mask:0xf bank_mask:0xf
    v_dot2c_f32_bf16_dpp v38, v68, v245 quad_perm:[3,3,3,3] row_mask:0xf bank_mask:0xf
    v_dot2c_f32_bf16_dpp v40, v68, v246 quad_perm:[3,3,3,3] row_mask:0xf bank_mask:0xf
    v_dot2c_f32_bf16_dpp v42, v68, v247 quad_perm:[3,3,3,3] row_mask:0xf bank_mask:0xf
    v_dot2c_f32_bf16_dpp v37, v92, v244 quad_perm:[3,3,3,3] row_mask:0xf bank_mask:0xf
    v_dot2c_f32_bf16_dpp v39, v92, v245 quad_perm:[3,3,3,3] row_mask:0xf bank_mask:0xf
    v_dot2c_f32_bf16_dpp v41, v92, v246 quad_perm:[3,3,3,3] row_mask:0xf bank_mask:0xf
    v_dot2c_f32_bf16_dpp v43, v92, v247 quad_perm:[3,3,3,3] row_mask:0xf bank_mask:0xf
    v_dot2c_f32_bf16_dpp v44, v70, v244 quad_perm:[3,3,3,3] row_mask:0xf bank_mask:0xf
    v_dot2c_f32_bf16_dpp v46, v70, v245 quad_perm:[3,3,3,3] row_mask:0xf bank_mask:0xf
    v_dot2c_f32_bf16_dpp v48, v70, v246 quad_perm:[3,3,3,3] row_mask:0xf bank_mask:0xf
    v_dot2c_f32_bf16_dpp v50, v70, v247 quad_perm:[3,3,3,3] row_mask:0xf bank_mask:0xf
    v_dot2c_f32_bf16_dpp v45, v93, v244 quad_perm:[3,3,3,3] row_mask:0xf bank_mask:0xf
    v_dot2c_f32_bf16_dpp v47, v93, v245 quad_perm:[3,3,3,3] row_mask:0xf bank_mask:0xf
    v_dot2c_f32_bf16_dpp v49, v93, v246 quad_perm:[3,3,3,3] row_mask:0xf bank_mask:0xf
    v_dot2c_f32_bf16_dpp v51, v93, v247 quad_perm:[3,3,3,3] row_mask:0xf bank_mask:0xf
    v_lshlrev_b32 v92, 16, v69
    v_lshlrev_b32 v93, 16, v71
    v_dot2c_f32_bf16_dpp v36, v69, v248 quad_perm:[0,0,0,0] row_mask:0xf bank_mask:0xf
    v_dot2c_f32_bf16_dpp v38, v69, v249 quad_perm:[0,0,0,0] row_mask:0xf bank_mask:0xf
    v_dot2c_f32_bf16_dpp v40, v69, v250 quad_perm:[0,0,0,0] row_mask:0xf bank_mask:0xf
    v_dot2c_f32_bf16_dpp v42, v69, v251 quad_perm:[0,0,0,0] row_mask:0xf bank_mask:0xf
    v_dot2c_f32_bf16_dpp v37, v92, v248 quad_perm:[0,0,0,0] row_mask:0xf bank_mask:0xf
    v_dot2c_f32_bf16_dpp v39, v92, v249 quad_perm:[0,0,0,0] row_mask:0xf bank_mask:0xf
    v_dot2c_f32_bf16_dpp v41, v92, v250 quad_perm:[0,0,0,0] row_mask:0xf bank_mask:0xf
    v_dot2c_f32_bf16_dpp v43, v92, v251 quad_perm:[0,0,0,0] row_mask:0xf bank_mask:0xf
    v_dot2c_f32_bf16_dpp v44, v71, v248 quad_perm:[0,0,0,0] row_mask:0xf bank_mask:0xf
    v_dot2c_f32_bf16_dpp v46, v71, v249 quad_perm:[0,0,0,0] row_mask:0xf bank_mask:0xf
    v_dot2c_f32_bf16_dpp v48, v71, v250 quad_perm:[0,0,0,0] row_mask:0xf bank_mask:0xf
    v_dot2c_f32_bf16_dpp v50, v71, v251 quad_perm:[0,0,0,0] row_mask:0xf bank_mask:0xf
    v_dot2c_f32_bf16_dpp v45, v93, v248 quad_perm:[0,0,0,0] row_mask:0xf bank_mask:0xf
    v_dot2c_f32_bf16_dpp v47, v93, v249 quad_perm:[0,0,0,0] row_mask:0xf bank_mask:0xf
    v_dot2c_f32_bf16_dpp v49, v93, v250 quad_perm:[0,0,0,0] row_mask:0xf bank_mask:0xf
    v_dot2c_f32_bf16_dpp v51, v93, v251 quad_perm:[0,0,0,0] row_mask:0xf bank_mask:0xf
    s_waitcnt vmcnt(4)
    buffer_load_dwordx4 v[116:119], v8, s[44:47], s26 offen nt
    v_dot2c_f32_bf16_dpp v36, v69, v252 quad_perm:[1,1,1,1] row_mask:0xf bank_mask:0xf
    v_dot2c_f32_bf16_dpp v38, v69, v253 quad_perm:[1,1,1,1] row_mask:0xf bank_mask:0xf
    v_dot2c_f32_bf16_dpp v40, v69, v254 quad_perm:[1,1,1,1] row_mask:0xf bank_mask:0xf
    v_dot2c_f32_bf16_dpp v42, v69, v255 quad_perm:[1,1,1,1] row_mask:0xf bank_mask:0xf
    v_dot2c_f32_bf16_dpp v37, v92, v252 quad_perm:[1,1,1,1] row_mask:0xf bank_mask:0xf
    v_dot2c_f32_bf16_dpp v39, v92, v253 quad_perm:[1,1,1,1] row_mask:0xf bank_mask:0xf
    v_dot2c_f32_bf16_dpp v41, v92, v254 quad_perm:[1,1,1,1] row_mask:0xf bank_mask:0xf
    v_dot2c_f32_bf16_dpp v43, v92, v255 quad_perm:[1,1,1,1] row_mask:0xf bank_mask:0xf
    v_dot2c_f32_bf16_dpp v44, v71, v252 quad_perm:[1,1,1,1] row_mask:0xf bank_mask:0xf
    v_dot2c_f32_bf16_dpp v46, v71, v253 quad_perm:[1,1,1,1] row_mask:0xf bank_mask:0xf
    v_dot2c_f32_bf16_dpp v48, v71, v254 quad_perm:[1,1,1,1] row_mask:0xf bank_mask:0xf
    v_dot2c_f32_bf16_dpp v50, v71, v255 quad_perm:[1,1,1,1] row_mask:0xf bank_mask:0xf
    v_dot2c_f32_bf16_dpp v45, v93, v252 quad_perm:[1,1,1,1] row_mask:0xf bank_mask:0xf
    v_dot2c_f32_bf16_dpp v47, v93, v253 quad_perm:[1,1,1,1] row_mask:0xf bank_mask:0xf
    v_dot2c_f32_bf16_dpp v49, v93, v254 quad_perm:[1,1,1,1] row_mask:0xf bank_mask:0xf
    v_dot2c_f32_bf16_dpp v51, v93, v255 quad_perm:[1,1,1,1] row_mask:0xf bank_mask:0xf
    v_fma_f32 v52, v52, s90, v72
    v_exp_f32 v52, v52
    s_nop 0
    v_cvt_pk_bf16_f32 v52, v52, 0
    s_waitcnt vmcnt(4)
    buffer_load_dwordx4 v[120:123], v9, s[44:47], s26 offen nt
    v_dot2c_f32_bf16_dpp v36, v69, v100 quad_perm:[2,2,2,2] row_mask:0xf bank_mask:0xf
    v_dot2c_f32_bf16_dpp v38, v69, v101 quad_perm:[2,2,2,2] row_mask:0xf bank_mask:0xf
    v_dot2c_f32_bf16_dpp v40, v69, v102 quad_perm:[2,2,2,2] row_mask:0xf bank_mask:0xf
    v_dot2c_f32_bf16_dpp v42, v69, v103 quad_perm:[2,2,2,2] row_mask:0xf bank_mask:0xf
    v_dot2c_f32_bf16_dpp v37, v92, v100 quad_perm:[2,2,2,2] row_mask:0xf bank_mask:0xf
    v_dot2c_f32_bf16_dpp v39, v92, v101 quad_perm:[2,2,2,2] row_mask:0xf bank_mask:0xf
    v_dot2c_f32_bf16_dpp v41, v92, v102 quad_perm:[2,2,2,2] row_mask:0xf bank_mask:0xf
    v_dot2c_f32_bf16_dpp v43, v92, v103 quad_perm:[2,2,2,2] row_mask:0xf bank_mask:0xf
    v_dot2c_f32_bf16_dpp v44, v71, v100 quad_perm:[2,2,2,2] row_mask:0xf bank_mask:0xf
    v_dot2c_f32_bf16_dpp v46, v71, v101 quad_perm:[2,2,2,2] row_mask:0xf bank_mask:0xf
    v_dot2c_f32_bf16_dpp v48, v71, v102 quad_perm:[2,2,2,2] row_mask:0xf bank_mask:0xf
    v_dot2c_f32_bf16_dpp v50, v71, v103 quad_perm:[2,2,2,2] row_mask:0xf bank_mask:0xf
    v_dot2c_f32_bf16_dpp v45, v93, v100 quad_perm:[2,2,2,2] row_mask:0xf bank_mask:0xf
    v_dot2c_f32_bf16_dpp v47, v93, v101 quad_perm:[2,2,2,2] row_mask:0xf bank_mask:0xf
    v_dot2c_f32_bf16_dpp v49, v93, v102 quad_perm:[2,2,2,2] row_mask:0xf bank_mask:0xf
    v_dot2c_f32_bf16_dpp v51, v93, v103 quad_perm:[2,2,2,2] row_mask:0xf bank_mask:0xf
    s_waitcnt vmcnt(4)
    s_add_u32 s86, s26, 0x144000
    s_and_b32 s86, s86, 0x3fffff
    buffer_load_dwordx4 v[124:127], v6, s[44:47], s86 offen nt
    v_dot2c_f32_bf16_dpp v36, v69, v104 quad_perm:[3,3,3,3] row_mask:0xf bank_mask:0xf
    v_dot2c_f32_bf16_dpp v38, v69, v105 quad_perm:[3,3,3,3] row_mask:0xf bank_mask:0xf
    v_dot2c_f32_bf16_dpp v40, v69, v106 quad_perm:[3,3,3,3] row_mask:0xf bank_mask:0xf
    v_dot2c_f32_bf16_dpp v42, v69, v107 quad_perm:[3,3,3,3] row_mask:0xf bank_mask:0xf
    v_dot2c_f32_bf16_dpp v37, v92, v104 quad_perm:[3,3,3,3] row_mask:0xf bank_mask:0xf
    v_dot2c_f32_bf16_dpp v39, v92, v105 quad_perm:[3,3,3,3] row_mask:0xf bank_mask:0xf
    v_dot2c_f32_bf16_dpp v41, v92, v106 quad_perm:[3,3,3,3] row_mask:0xf bank_mask:0xf
    v_dot2c_f32_bf16_dpp v43, v92, v107 quad_perm:[3,3,3,3] row_mask:0xf bank_mask:0xf
    v_dot2c_f32_bf16_dpp v44, v71, v104 quad_perm:[3,3,3,3] row_mask:0xf bank_mask:0xf
    v_dot2c_f32_bf16_dpp v46, v71, v105 quad_perm:[3,3,3,3] row_mask:0xf bank_mask:0xf
    v_dot2c_f32_bf16_dpp v48, v71, v106 quad_perm:[3,3,3,3] row_mask:0xf bank_mask:0xf
    v_dot2c_f32_bf16_dpp v50, v71, v107 quad_perm:[3,3,3,3] row_mask:0xf bank_mask:0xf
    v_dot2c_f32_bf16_dpp v45, v93, v104 quad_perm:[3,3,3,3] row_mask:0xf bank_mask:0xf
    v_dot2c_f32_bf16_dpp v47, v93, v105 quad_perm:[3,3,3,3] row_mask:0xf bank_mask:0xf
    v_dot2c_f32_bf16_dpp v49, v93, v106 quad_perm:[3,3,3,3] row_mask:0xf bank_mask:0xf
    v_dot2c_f32_bf16_dpp v51, v93, v107 quad_perm:[3,3,3,3] row_mask:0xf bank_mask:0xf
    s_waitcnt vmcnt(4)
    buffer_load_dwordx4 v[128:131], v7, s[44:47], s86 offen nt
    v_lshlrev_b32 v92, 16, v52
    v_dot2c_f32_bf16_dpp v28, v52, v108 quad_perm:[0,0,0,0] row_mask:0xf bank_mask:0xf
    v_dot2c_f32_bf16_dpp v30, v52, v109 quad_perm:[0,0,0,0] row_mask:0xf bank_mask:0xf
    v_dot2c_f32_bf16_dpp v32, v52, v110 quad_perm:[0,0,0,0] row_mask:0xf bank_mask:0xf
    v_dot2c_f32_bf16_dpp v34, v52, v111 quad_perm:[0,0,0,0] row_mask:0xf bank_mask:0xf
    v_dot2c_f32_bf16_dpp v29, v92, v108 quad_perm:[0,0,0,0] row_mask:0xf bank_mask:0xf
    v_dot2c_f32_bf16_dpp v31, v92, v109 quad_perm:[0,0,0,0] row_mask:0xf bank_mask:0xf
    v_dot2c_f32_bf16_dpp v33, v92, v110 quad_perm:[0,0,0,0] row_mask:0xf bank_mask:0xf
    v_dot2c_f32_bf16_dpp v35, v92, v111 quad_perm:[0,0,0,0] row_mask:0xf bank_mask:0xf
    s_waitcnt vmcnt(4)
    buffer_load_dwordx4 v[132:135], v8, s[44:47], s86 offen nt
    v_dot2c_f32_bf16_dpp v28, v52, v112 quad_perm:[1,1,1,1] row_mask:0xf bank_mask:0xf
    v_dot2c_f32_bf16_dpp v30, v52, v113 quad_perm:[1,1,1,1] row_mask:0xf bank_mask:0xf
    v_dot2c_f32_bf16_dpp v32, v52, v114 quad_perm:[1,1,1,1] row_mask:0xf bank_mask:0xf
    v_dot2c_f32_bf16_dpp v34, v52, v115 quad_perm:[1,1,1,1] row_mask:0xf bank_mask:0xf
    v_dot2c_f32_bf16_dpp v29, v92, v112 quad_perm:[1,1,1,1] row_mask:0xf bank_mask:0xf
    v_dot2c_f32_bf16_dpp v31, v92, v113 quad_perm:[1,1,1,1] row_mask:0xf bank_mask:0xf
    v_dot2c_f32_bf16_dpp v33, v92, v114 quad_perm:[1,1,1,1] row_mask:0xf bank_mask:0xf
    v_dot2c_f32_bf16_dpp v35, v92, v115 quad_perm:[1,1,1,1] row_mask:0xf bank_mask:0xf
    v_fma_f32 v53, v53, s90, v72
    v_exp_f32 v53, v53
    s_nop 0
    v_cvt_pk_bf16_f32 v53, v53, 0
    s_waitcnt vmcnt(4)
    buffer_load_dwordx4 v[136:139], v9, s[44:47], s86 offen nt
    v_dot2c_f32_bf16_dpp v28, v52, v116 quad_perm:[2,2,2,2] row_mask:0xf bank_mask:0xf
    v_dot2c_f32_bf16_dpp v30, v52, v117 quad_perm:[2,2,2,2] row_mask:0xf bank_mask:0xf
    v_dot2c_f32_bf16_dpp v32, v52, v118 quad_perm:[2,2,2,2] row_mask:0xf bank_mask:0xf
    v_dot2c_f32_bf16_dpp v34, v52, v119 quad_perm:[2,2,2,2] row_mask:0xf bank_mask:0xf
    v_dot2c_f32_bf16_dpp v29, v92, v116 quad_perm:[2,2,2,2] row_mask:0xf bank_mask:0xf
    v_dot2c_f32_bf16_dpp v31, v92, v117 quad_perm:[2,2,2,2] row_mask:0xf bank_mask:0xf
    v_dot2c_f32_bf16_dpp v33, v92, v118 quad_perm:[2,2,2,2] row_mask:0xf bank_mask:0xf
    v_dot2c_f32_bf16_dpp v35, v92, v119 quad_perm:[2,2,2,2] row_mask:0xf bank_mask:0xf
    v_permlane32_swap_b32 v36, v40
    v_permlane32_swap_b32 v37, v41
    v_permlane32_swap_b32 v38, v42
    v_permlane32_swap_b32 v39, v43
    v_pk_add_f32 v[36:37], v[36:37], v[40:41]
    v_pk_add_f32 v[38:39], v[38:39], v[42:43]
    s_nop 1
    v_permlane16_swap_b32 v36, v38
    v_permlane16_swap_b32 v37, v39
    v_pk_add_f32 v[36:37], v[36:37], v[38:39]
    s_nop 1
    v_add_f32_dpp v37, v37, v37 row_ror:8 row_mask:0xf bank_mask:0xc
    s_nop 1
    v_add_f32_dpp v37, v36, v36 row_ror:8 row_mask:0xf bank_mask:0x3
    v_and_or_b32 v68, v37, s31, v94
    s_waitcnt vmcnt(4)
    s_add_u32 s86, s86, 0x144000
    s_and_b32 s86, s86, 0x3fffff
    buffer_load_dwordx4 v[140:143], v6, s[44:47], s86 offen nt
    v_dot2c_f32_bf16_dpp v28, v52, v120 quad_perm:[3,3,3,3] row_mask:0xf bank_mask:0xf
    v_dot2c_f32_bf16_dpp v30, v52, v121 quad_perm:[3,3,3,3] row_mask:0xf bank_mask:0xf
    v_dot2c_f32_bf16_dpp v32, v52, v122 quad_perm:[3,3,3,3] row_mask:0xf bank_mask:0xf
    v_dot2c_f32_bf16_dpp v34, v52, v123 quad_perm:[3,3,3,3] row_mask:0xf bank_mask:0xf
    v_dot2c_f32_bf16_dpp v29, v92, v120 quad_perm:[3,3,3,3] row_mask:0xf bank_mask:0xf
    v_dot2c_f32_bf16_dpp v31, v92, v121 quad_perm:[3,3,3,3] row_mask:0xf bank_mask:0xf
    v_dot2c_f32_bf16_dpp v33, v92, v122 quad_perm:[3,3,3,3] row_mask:0xf bank_mask:0xf
    v_dot2c_f32_bf16_dpp v35, v92, v123 quad_perm:[3,3,3,3] row_mask:0xf bank_mask:0xf
    s_waitcnt vmcnt(4)
    buffer_load_dwordx4 v[144:147], v7, s[44:47], s86 offen nt
    v_lshlrev_b32 v92, 16, v53
    v_dot2c_f32_bf16_dpp v28, v53, v124 quad_perm:[0,0,0,0] row_mask:0xf bank_mask:0xf
    v_dot2c_f32_bf16_dpp v30, v53, v125 quad_perm:[0,0,0,0] row_mask:0xf bank_mask:0xf
    v_dot2c_f32_bf16_dpp v32, v53, v126 quad_perm:[0,0,0,0] row_mask:0xf bank_mask:0xf
    v_dot2c_f32_bf16_dpp v34, v53, v127 quad_perm:[0,0,0,0] row_mask:0xf bank_mask:0xf
    v_dot2c_f32_bf16_dpp v29, v92, v124 quad_perm:[0,0,0,0] row_mask:0xf bank_mask:0xf
    v_dot2c_f32_bf16_dpp v31, v92, v125 quad_perm:[0,0,0,0] row_mask:0xf bank_mask:0xf
    v_dot2c_f32_bf16_dpp v33, v92, v126 quad_perm:[0,0,0,0] row_mask:0xf bank_mask:0xf
    v_dot2c_f32_bf16_dpp v35, v92, v127 quad_perm:[0,0,0,0] row_mask:0xf bank_mask:0xf
    v_permlane32_swap_b32 v44, v48
    v_permlane32_swap_b32 v45, v49
    v_permlane32_swap_b32 v46, v50
    v_permlane32_swap_b32 v47, v51
    v_pk_add_f32 v[44:45], v[44:45], v[48:49]
    v_pk_add_f32 v[46:47], v[46:47], v[50:51]
    s_nop 1
    v_permlane16_swap_b32 v44, v46
    v_permlane16_swap_b32 v45, v47
    v_pk_add_f32 v[44:45], v[44:45], v[46:47]
    s_nop 1
    v_add_f32_dpp v45, v45, v45 row_ror:8 row_mask:0xf bank_mask:0xc
    s_nop 1
    v_add_f32_dpp v45, v44, v44 row_ror:8 row_mask:0xf bank_mask:0x3
    v_and_or_b32 v69, v45, s31, v94
    v_mov_b32 v44, 0
    v_mov_b32 v45, 0
    v_mov_b32 v46, 0
    v_mov_b32 v47, 0
    v_mov_b32 v48, 0
    v_mov_b32 v49, 0
    v_mov_b32 v50, 0
    v_mov_b32 v51, 0
    s_waitcnt vmcnt(4)
    buffer_load_dwordx4 v[148:151], v8, s[44:47], s86 offen nt
    v_dot2c_f32_bf16_dpp v28, v53, v128 quad_perm:[1,1,1,1] row_mask:0xf bank_mask:0xf
    v_dot2c_f32_bf16_dpp v30, v53, v129 quad_perm:[1,1,1,1] row_mask:0xf bank_mask:0xf
    v_dot2c_f32_bf16_dpp v32, v53, v130 quad_perm:[1,1,1,1] row_mask:0xf bank_mask:0xf
    v_dot2c_f32_bf16_dpp v34, v53, v131 quad_perm:[1,1,1,1] row_mask:0xf bank_mask:0xf
    v_dot2c_f32_bf16_dpp v29, v92, v128 quad_perm:[1,1,1,1] row_mask:0xf bank_mask:0xf
    v_dot2c_f32_bf16_dpp v31, v92, v129 quad_perm:[1,1,1,1] row_mask:0xf bank_mask:0xf
    v_dot2c_f32_bf16_dpp v33, v92, v130 quad_perm:[1,1,1,1] row_mask:0xf bank_mask:0xf
    v_dot2c_f32_bf16_dpp v35, v92, v131 quad_perm:[1,1,1,1] row_mask:0xf bank_mask:0xf
    v_fma_f32 v54, v54, s90, v72
    v_exp_f32 v54, v54
    s_nop 0
    v_cvt_pk_bf16_f32 v54, v54, 0
    s_waitcnt vmcnt(4)
    buffer_load_dwordx4 v[152:155], v9, s[44:47], s86 offen nt
    v_dot2c_f32_bf16_dpp v28, v53, v132 quad_perm:[2,2,2,2] row_mask:0xf bank_mask:0xf
    v_dot2c_f32_bf16_dpp v30, v53, v133 quad_perm:[2,2,2,2] row_mask:0xf bank_mask:0xf
    v_dot2c_f32_bf16_dpp v32, v53, v134 quad_perm:[2,2,2,2] row_mask:0xf bank_mask:0xf
    v_dot2c_f32_bf16_dpp v34, v53, v135 quad_perm:[2,2,2,2] row_mask:0xf bank_mask:0xf
    v_dot2c_f32_bf16_dpp v29, v92, v132 quad_perm:[2,2,2,2] row_mask:0xf bank_mask:0xf
    v_dot2c_f32_bf16_dpp v31, v92, v133 quad_perm:[2,2,2,2] row_mask:0xf bank_mask:0xf
    v_dot2c_f32_bf16_dpp v33, v92, v134 quad_perm:[2,2,2,2] row_mask:0xf bank_mask:0xf
    v_dot2c_f32_bf16_dpp v35, v92, v135 quad_perm:[2,2,2,2] row_mask:0xf bank_mask:0xf
    s_waitcnt vmcnt(4)
    s_add_u32 s86, s86, 0x144000
    s_and_b32 s86, s86, 0x3fffff
    buffer_load_dwordx4 v[156:159], v6, s[44:47], s86 offen nt
    v_dot2c_f32_bf16_dpp v28, v53, v136 quad_perm:[3,3,3,3] row_mask:0xf bank_mask:0xf
    v_dot2c_f32_bf16_dpp v30, v53, v137 quad_perm:[3,3,3,3] row_mask:0xf bank_mask:0xf
    v_dot2c_f32_bf16_dpp v32, v53, v138 quad_perm:[3,3,3,3] row_mask:0xf bank_mask:0xf
    v_dot2c_f32_bf16_dpp v34, v53, v139 quad_perm:[3,3,3,3] row_mask:0xf bank_mask:0xf
    v_dot2c_f32_bf16_dpp v29, v92, v136 quad_perm:[3,3,3,3] row_mask:0xf bank_mask:0xf
    v_dot2c_f32_bf16_dpp v31, v92, v137 quad_perm:[3,3,3,3] row_mask:0xf bank_mask:0xf
    v_dot2c_f32_bf16_dpp v33, v92, v138 quad_perm:[3,3,3,3] row_mask:0xf bank_mask:0xf
    v_dot2c_f32_bf16_dpp v35, v92, v139 quad_perm:[3,3,3,3] row_mask:0xf bank_mask:0xf
    v_mov_b32 v78, v54
    v_mov_b32 v81, v55
    v_mov_b32 v82, 2
    v_add_u32 v83, 16, v97
    s_mov_b32 s77, 5
    s_nop 3
.p2align 3
L_vloop:
    v_lshlrev_b32 v92, 16, v78
    s_waitcnt vmcnt(4)
    buffer_load_dwordx4 v[160:163], v7, s[44:47], s86 offen nt
    v_dot2c_f32_bf16_dpp v28, v78, v140 quad_perm:[0,0,0,0] row_mask:0xf bank_mask:0xf
    v_dot2c_f32_bf16_dpp v30, v78, v141 quad_perm:[0,0,0,0] row_mask:0xf bank_mask:0xf
    v_dot2c_f32_bf16_dpp v32, v78, v142 quad_perm:[0,0,0,0] row_mask:0xf bank_mask:0xf
    v_dot2c_f32_bf16_dpp v34, v78, v143 quad_perm:[0,0,0,0] row_mask:0xf bank_mask:0xf
    v_dot2c_f32_bf16_dpp v29, v92, v140 quad_perm:[0,0,0,0] row_mask:0xf bank_mask:0xf
    v_dot2c_f32_bf16_dpp v31, v92, v141 quad_perm:[0,0,0,0] row_mask:0xf bank_mask:0xf
    v_dot2c_f32_bf16_dpp v33, v92, v142 quad_perm:[0,0,0,0] row_mask:0xf bank_mask:0xf
    v_dot2c_f32_bf16_dpp v35, v92, v143 quad_perm:[0,0,0,0] row_mask:0xf bank_mask:0xf
    s_waitcnt vmcnt(4)
    buffer_load_dwordx4 v[164:167], v8, s[44:47], s86 offen nt
    v_dot2c_f32_bf16_dpp v28, v78, v144 quad_perm:[1,1,1,1] row_mask:0xf bank_mask:0xf
    v_dot2c_f32_bf16_dpp v30, v78, v145 quad_perm:[1,1,1,1] row_mask:0xf bank_mask:0xf
    v_dot2c_f32_bf16_dpp v32, v78, v146 quad_perm:[1,1,1,1] row_mask:0xf bank_mask:0xf
    v_dot2c_f32_bf16_dpp v34, v78, v147 quad_perm:[1,1,1,1] row_mask:0xf bank_mask:0xf
    v_dot2c_f32_bf16_dpp v29, v92, v144 quad_perm:[1,1,1,1] row_mask:0xf bank_mask:0xf
    v_dot2c_f32_bf16_dpp v31, v92, v145 quad_perm:[1,1,1,1] row_mask:0xf bank_mask:0xf
    v_dot2c_f32_bf16_dpp v33, v92, v146 quad_perm:[1,1,1,1] row_mask:0xf bank_mask:0xf
    v_dot2c_f32_bf16_dpp v35, v92, v147 quad_perm:[1,1,1,1] row_mask:0xf bank_mask:0xf
    v_fma_f32 v79, v81, s90, v72
    v_exp_f32 v79, v79
    ds_read_b64 v[80:81], v83 offset:0
    v_cvt_pk_bf16_f32 v79, v79, 0
    v_add_u32 v83, 8, v83
    s_waitcnt vmcnt(4)
    buffer_load_dwordx4 v[168:171], v9, s[44:47], s86 offen nt
    s_add_u32 s86, s86, 0x144000
    s_and_b32 s86, s86, 0x3fffff
    v_dot2c_f32_bf16_dpp v28, v78, v148 quad_perm:[2,2,2,2] row_mask:0xf bank_mask:0xf
    v_dot2c_f32_bf16_dpp v30, v78, v149 quad_perm:[2,2,2,2] row_mask:0xf bank_mask:0xf
    v_dot2c_f32_bf16_dpp v32, v78, v150 quad_perm:[2,2,2,2] row_mask:0xf bank_mask:0xf
    v_dot2c_f32_bf16_dpp v34, v78, v151 quad_perm:[2,2,2,2] row_mask:0xf bank_mask:0xf
    v_dot2c_f32_bf16_dpp v29, v92, v148 quad_perm:[2,2,2,2] row_mask:0xf bank_mask:0xf
    v_dot2c_f32_bf16_dpp v31, v92, v149 quad_perm:[2,2,2,2] row_mask:0xf bank_mask:0xf
    v_dot2c_f32_bf16_dpp v33, v92, v150 quad_perm:[2,2,2,2] row_mask:0xf bank_mask:0xf
    v_dot2c_f32_bf16_dpp v35, v92, v151 quad_perm:[2,2,2,2] row_mask:0xf bank_mask:0xf
    ds_write_b32 v95, v82 offset:2568
    v_add_u32 v82, 1, v82
    s_waitcnt vmcnt(4)
    buffer_load_dwordx4 v[140:143], v6, s[44:47], s86 offen nt
    v_dot2c_f32_bf16_dpp v28, v78, v152 quad_perm:[3,3,3,3] row_mask:0xf bank_mask:0xf
    v_dot2c_f32_bf16_dpp v30, v78, v153 quad_perm:[3,3,3,3] row_mask:0xf bank_mask:0xf
    v_dot2c_f32_bf16_dpp v32, v78, v154 quad_perm:[3,3,3,3] row_mask:0xf bank_mask:0xf
    v_dot2c_f32_bf16_dpp v34, v78, v155 quad_perm:[3,3,3,3] row_mask:0xf bank_mask:0xf
    v_dot2c_f32_bf16_dpp v29, v92, v152 quad_perm:[3,3,3,3] row_mask:0xf bank_mask:0xf
    v_dot2c_f32_bf16_dpp v31, v92, v153 quad_perm:[3,3,3,3] row_mask:0xf bank_mask:0xf
    v_dot2c_f32_bf16_dpp v33, v92, v154 quad_perm:[3,3,3,3] row_mask:0xf bank_mask:0xf
    v_dot2c_f32_bf16_dpp v35, v92, v155 quad_perm:[3,3,3,3] row_mask:0xf bank_mask:0xf
    v_lshlrev_b32 v92, 16, v79
    s_waitcnt vmcnt(4)
    buffer_load_dwordx4 v[144:147], v7, s[44:47], s86 offen nt
    v_dot2c_f32_bf16_dpp v28, v79, v156 quad_perm:[0,0,0,0] row_mask:0xf bank_mask:0xf
    v_dot2c_f32_bf16_dpp v30, v79, v157 quad_perm:[0,0,0,0] row_mask:0xf bank_mask:0xf
    v_dot2c_f32_bf16_dpp v32, v79, v158 quad_perm:[0,0,0,0] row_mask:0xf bank_mask:0xf
    v_dot2c_f32_bf16_dpp v34, v79, v159 quad_perm:[0,0,0,0] row_mask:0xf bank_mask:0xf
    v_dot2c_f32_bf16_dpp v29, v92, v156 quad_perm:[0,0,0,0] row_mask:0xf bank_mask:0xf
    v_dot2c_f32_bf16_dpp v31, v92, v157 quad_perm:[0,0,0,0] row_mask:0xf bank_mask:0xf
    v_dot2c_f32_bf16_dpp v33, v92, v158 quad_perm:[0,0,0,0] row_mask:0xf bank_mask:0xf
    v_dot2c_f32_bf16_dpp v35, v92, v159 quad_perm:[0,0,0,0] row_mask:0xf bank_mask:0xf
    s_waitcnt vmcnt(4)
    buffer_load_dwordx4 v[148:151], v8, s[44:47], s86 offen nt
    v_dot2c_f32_bf16_dpp v28, v79, v160 quad_perm:[1,1,1,1] row_mask:0xf bank_mask:0xf
    v_dot2c_f32_bf16_dpp v30, v79, v161 quad_perm:[1,1,1,1] row_mask:0xf bank_mask:0xf
    v_dot2c_f32_bf16_dpp v32, v79, v162 quad_perm:[1,1,1,1] row_mask:0xf bank_mask:0xf
    v_dot2c_f32_bf16_dpp v34, v79, v163 quad_perm:[1,1,1,1] row_mask:0xf bank_mask:0xf
    v_dot2c_f32_bf16_dpp v29, v92, v160 quad_perm:[1,1,1,1] row_mask:0xf bank_mask:0xf
    v_dot2c_f32_bf16_dpp v31, v92, v161 quad_perm:[1,1,1,1] row_mask:0xf bank_mask:0xf
    v_dot2c_f32_bf16_dpp v33, v92, v162 quad_perm:[1,1,1,1] row_mask:0xf bank_mask:0xf
    v_dot2c_f32_bf16_dpp v35, v92, v163 quad_perm:[1,1,1,1] row_mask:0xf bank_mask:0xf
    s_waitcnt lgkmcnt(0)
    v_fma_f32 v78, v80, s90, v72
    v_exp_f32 v78, v78
    s_sub_u32 s77, s77, 1
    v_cvt_pk_bf16_f32 v78, v78, 0
    s_waitcnt vmcnt(4)
    buffer_load_dwordx4 v[152:155], v9, s[44:47], s86 offen nt
    s_add_u32 s86, s86, 0x144000
    s_and_b32 s86, s86, 0x3fffff
    v_dot2c_f32_bf16_dpp v28, v79, v164 quad_perm:[2,2,2,2] row_mask:0xf bank_mask:0xf
    v_dot2c_f32_bf16_dpp v30, v79, v165 quad_perm:[2,2,2,2] row_mask:0xf bank_mask:0xf
    v_dot2c_f32_bf16_dpp v32, v79, v166 quad_perm:[2,2,2,2] row_mask:0xf bank_mask:0xf
    v_dot2c_f32_bf16_dpp v34, v79, v167 quad_perm:[2,2,2,2] row_mask:0xf bank_mask:0xf
    v_dot2c_f32_bf16_dpp v29, v92, v164 quad_perm:[2,2,2,2] row_mask:0xf bank_mask:0xf
    v_dot2c_f32_bf16_dpp v31, v92, v165 quad_perm:[2,2,2,2] row_mask:0xf bank_mask:0xf
    v_dot2c_f32_bf16_dpp v33, v92, v166 quad_perm:[2,2,2,2] row_mask:0xf bank_mask:0xf
    v_dot2c_f32_bf16_dpp v35, v92, v167 quad_perm:[2,2,2,2] row_mask:0xf bank_mask:0xf
    ds_write_b32 v95, v82 offset:2568
    v_add_u32 v82, 1, v82
    s_waitcnt vmcnt(4)
    buffer_load_dwordx4 v[156:159], v6, s[44:47], s86 offen nt
    v_dot2c_f32_bf16_dpp v28, v79, v168 quad_perm:[3,3,3,3] row_mask:0xf bank_mask:0xf
    v_dot2c_f32_bf16_dpp v30, v79, v169 quad_perm:[3,3,3,3] row_mask:0xf bank_mask:0xf
    v_dot2c_f32_bf16_dpp v32, v79, v170 quad_perm:[3,3,3,3] row_mask:0xf bank_mask:0xf
    v_dot2c_f32_bf16_dpp v34, v79, v171 quad_perm:[3,3,3,3] row_mask:0xf bank_mask:0xf
    v_dot2c_f32_bf16_dpp v29, v92, v168 quad_perm:[3,3,3,3] row_mask:0xf bank_mask:0xf
    v_dot2c_f32_bf16_dpp v31, v92, v169 quad_perm:[3,3,3,3] row_mask:0xf bank_mask:0xf
    v_dot2c_f32_bf16_dpp v33, v92, v170 quad_perm:[3,3,3,3] row_mask:0xf bank_mask:0xf
    v_dot2c_f32_bf16_dpp v35, v92, v171 quad_perm:[3,3,3,3] row_mask:0xf bank_mask:0xf
    s_cmp_lg_u32 s77, 0
    s_cbranch_scc1 L_vloop
    s_waitcnt vmcnt(4)
    buffer_load_dwordx4 v[160:163], v7, s[44:47], s86 offen nt
    buffer_load_dwordx4 v[164:167], v8, s[44:47], s86 offen nt
    v_lshlrev_b32 v92, 16, v78
    v_dot2c_f32_bf16_dpp v28, v78, v140 quad_perm:[0,0,0,0] row_mask:0xf bank_mask:0xf
    v_dot2c_f32_bf16_dpp v30, v78, v141 quad_perm:[0,0,0,0] row_mask:0xf bank_mask:0xf
    v_dot2c_f32_bf16_dpp v32, v78, v142 quad_perm:[0,0,0,0] row_mask:0xf bank_mask:0xf
    v_dot2c_f32_bf16_dpp v34, v78, v143 quad_perm:[0,0,0,0] row_mask:0xf bank_mask:0xf
    v_dot2c_f32_bf16_dpp v29, v92, v140 quad_perm:[0,0,0,0] row_mask:0xf bank_mask:0xf
    v_dot2c_f32_bf16_dpp v31, v92, v141 quad_perm:[0,0,0,0] row_mask:0xf bank_mask:0xf
    v_dot2c_f32_bf16_dpp v33, v92, v142 quad_perm:[0,0,0,0] row_mask:0xf bank_mask:0xf
    v_dot2c_f32_bf16_dpp v35, v92, v143 quad_perm:[0,0,0,0] row_mask:0xf bank_mask:0xf
    s_waitcnt vmcnt(5)
    buffer_load_dwordx4 v[168:171], v9, s[44:47], s86 offen nt
    s_add_u32 s86, s86, 0x144000
    s_and_b32 s86, s86, 0x3fffff
    buffer_load_dwordx4 v[188:191], v6, s[44:47], s86 offen nt
    v_dot2c_f32_bf16_dpp v28, v78, v144 quad_perm:[1,1,1,1] row_mask:0xf bank_mask:0xf
    v_dot2c_f32_bf16_dpp v30, v78, v145 quad_perm:[1,1,1,1] row_mask:0xf bank_mask:0xf
    v_dot2c_f32_bf16_dpp v32, v78, v146 quad_perm:[1,1,1,1] row_mask:0xf bank_mask:0xf
    v_dot2c_f32_bf16_dpp v34, v78, v147 quad_perm:[1,1,1,1] row_mask:0xf bank_mask:0xf
    v_dot2c_f32_bf16_dpp v29, v92, v144 quad_perm:[1,1,1,1] row_mask:0xf bank_mask:0xf
    v_dot2c_f32_bf16_dpp v31, v92, v145 quad_perm:[1,1,1,1] row_mask:0xf bank_mask:0xf
    v_dot2c_f32_bf16_dpp v33, v92, v146 quad_perm:[1,1,1,1] row_mask:0xf bank_mask:0xf
    v_dot2c_f32_bf16_dpp v35, v92, v147 quad_perm:[1,1,1,1] row_mask:0xf bank_mask:0xf
    v_fma_f32 v79, v65, s90, v72
    v_exp_f32 v79, v79
    s_nop 0
    v_cvt_pk_bf16_f32 v79, v79, 0
    s_waitcnt vmcnt(6)
    buffer_load_dwordx4 v[192:195], v7, s[44:47], s86 offen nt
    buffer_load_dwordx4 v[196:199], v8, s[44:47], s86 offen nt
    v_dot2c_f32_bf16_dpp v28, v78, v148 quad_perm:[2,2,2,2] row_mask:0xf bank_mask:0xf
    v_dot2c_f32_bf16_dpp v30, v78, v149 quad_perm:[2,2,2,2] row_mask:0xf bank_mask:0xf
    v_dot2c_f32_bf16_dpp v32, v78, v150 quad_perm:[2,2,2,2] row_mask:0xf bank_mask:0xf
    v_dot2c_f32_bf16_dpp v34, v78, v151 quad_perm:[2,2,2,2] row_mask:0xf bank_mask:0xf
    v_dot2c_f32_bf16_dpp v29, v92, v148 quad_perm:[2,2,2,2] row_mask:0xf bank_mask:0xf
    v_dot2c_f32_bf16_dpp v31, v92, v149 quad_perm:[2,2,2,2] row_mask:0xf bank_mask:0xf
    v_dot2c_f32_bf16_dpp v33, v92, v150 quad_perm:[2,2,2,2] row_mask:0xf bank_mask:0xf
    v_dot2c_f32_bf16_dpp v35, v92, v151 quad_perm:[2,2,2,2] row_mask:0xf bank_mask:0xf
    v_mov_b32 v82, 12
    ds_write_b32 v95, v82 offset:2568
    s_waitcnt vmcnt(7)
    buffer_load_dwordx4 v[200:203], v9, s[44:47], s86 offen nt
    s_add_u32 s86, s86, 0x144000
    s_and_b32 s86, s86, 0x3fffff
    buffer_load_dwordx4 v[204:207], v6, s[44:47], s86 offen nt
    v_dot2c_f32_bf16_dpp v28, v78, v152 quad_perm:[3,3,3,3] row_mask:0xf bank_mask:0xf
    v_dot2c_f32_bf16_dpp v30, v78, v153 quad_perm:[3,3,3,3] row_mask:0xf bank_mask:0xf
    v_dot2c_f32_bf16_dpp v32, v78, v154 quad_perm:[3,3,3,3] row_mask:0xf bank_mask:0xf
    v_dot2c_f32_bf16_dpp v34, v78, v155 quad_perm:[3,3,3,3] row_mask:0xf bank_mask:0xf
    v_dot2c_f32_bf16_dpp v29, v92, v152 quad_perm:[3,3,3,3] row_mask:0xf bank_mask:0xf
    v_dot2c_f32_bf16_dpp v31, v92, v153 quad_perm:[3,3,3,3] row_mask:0xf bank_mask:0xf
    v_dot2c_f32_bf16_dpp v33, v92, v154 quad_perm:[3,3,3,3] row_mask:0xf bank_mask:0xf
    v_dot2c_f32_bf16_dpp v35, v92, v155 quad_perm:[3,3,3,3] row_mask:0xf bank_mask:0xf
    s_waitcnt vmcnt(8)
    buffer_load_dwordx4 v[208:211], v7, s[44:47], s86 offen nt
    buffer_load_dwordx4 v[212:215], v8, s[44:47], s86 offen nt
    v_lshlrev_b32 v92, 16, v79
    v_dot2c_f32_bf16_dpp v28, v79, v156 quad_perm:[0,0,0,0] row_mask:0xf bank_mask:0xf
    v_dot2c_f32_bf16_dpp v30, v79, v157 quad_perm:[0,0,0,0] row_mask:0xf bank_mask:0xf
    v_dot2c_f32_bf16_dpp v32, v79, v158 quad_perm:[0,0,0,0] row_mask:0xf bank_mask:0xf
    v_dot2c_f32_bf16_dpp v34, v79, v159 quad_perm:[0,0,0,0] row_mask:0xf bank_mask:0xf
    v_dot2c_f32_bf16_dpp v29, v92, v156 quad_perm:[0,0,0,0] row_mask:0xf bank_mask:0xf
    v_dot2c_f32_bf16_dpp v31, v92, v157 quad_perm:[0,0,0,0] row_mask:0xf bank_mask:0xf
    v_dot2c_f32_bf16_dpp v33, v92, v158 quad_perm:[0,0,0,0] row_mask:0xf bank_mask:0xf
    v_dot2c_f32_bf16_dpp v35, v92, v159 quad_perm:[0,0,0,0] row_mask:0xf bank_mask:0xf
    s_waitcnt vmcnt(9)
    buffer_load_dwordx4 v[216:219], v9, s[44:47], s86 offen nt
    v_dot2c_f32_bf16_dpp v28, v79, v160 quad_perm:[1,1,1,1] row_mask:0xf bank_mask:0xf
    v_dot2c_f32_bf16_dpp v30, v79, v161 quad_perm:[1,1,1,1] row_mask:0xf bank_mask:0xf
    v_dot2c_f32_bf16_dpp v32, v79, v162 quad_perm:[1,1,1,1] row_mask:0xf bank_mask:0xf
    v_dot2c_f32_bf16_dpp v34, v79, v163 quad_perm:[1,1,1,1] row_mask:0xf bank_mask:0xf
    v_dot2c_f32_bf16_dpp v29, v92, v160 quad_perm:[1,1,1,1] row_mask:0xf bank_mask:0xf
    v_dot2c_f32_bf16_dpp v31, v92, v161 quad_perm:[1,1,1,1] row_mask:0xf bank_mask:0xf
    v_dot2c_f32_bf16_dpp v33, v92, v162 quad_perm:[1,1,1,1] row_mask:0xf bank_mask:0xf
    v_dot2c_f32_bf16_dpp v35, v92, v163 quad_perm:[1,1,1,1] row_mask:0xf bank_mask:0xf
    v_fma_f32 v78, v66, s90, v72
    v_exp_f32 v78, v78
    s_nop 0
    v_cvt_pk_bf16_f32 v78, v78, 0
    s_waitcnt vmcnt(9)
    v_dot2c_f32_bf16_dpp v28, v79, v164 quad_perm:[2,2,2,2] row_mask:0xf bank_mask:0xf
    v_dot2c_f32_bf16_dpp v30, v79, v165 quad_perm:[2,2,2,2] row_mask:0xf bank_mask:0xf
    v_dot2c_f32_bf16_dpp v32, v79, v166 quad_perm:[2,2,2,2] row_mask:0xf bank_mask:0xf
    v_dot2c_f32_bf16_dpp v34, v79, v167 quad_perm:[2,2,2,2] row_mask:0xf bank_mask:0xf
    v_dot2c_f32_bf16_dpp v29, v92, v164 quad_perm:[2,2,2,2] row_mask:0xf bank_mask:0xf
    v_dot2c_f32_bf16_dpp v31, v92, v165 quad_perm:[2,2,2,2] row_mask:0xf bank_mask:0xf
    v_dot2c_f32_bf16_dpp v33, v92, v166 quad_perm:[2,2,2,2] row_mask:0xf bank_mask:0xf
    v_dot2c_f32_bf16_dpp v35, v92, v167 quad_perm:[2,2,2,2] row_mask:0xf bank_mask:0xf
    v_mov_b32 v82, 13
    ds_write_b32 v95, v82 offset:2568
    s_waitcnt vmcnt(8)
    v_dot2c_f32_bf16_dpp v28, v79, v168 quad_perm:[3,3,3,3] row_mask:0xf bank_mask:0xf
    v_dot2c_f32_bf16_dpp v30, v79, v169 quad_perm:[3,3,3,3] row_mask:0xf bank_mask:0xf
    v_dot2c_f32_bf16_dpp v32, v79, v170 quad_perm:[3,3,3,3] row_mask:0xf bank_mask:0xf
    v_dot2c_f32_bf16_dpp v34, v79, v171 quad_perm:[3,3,3,3] row_mask:0xf bank_mask:0xf
    v_dot2c_f32_bf16_dpp v29, v92, v168 quad_perm:[3,3,3,3] row_mask:0xf bank_mask:0xf
    v_dot2c_f32_bf16_dpp v31, v92, v169 quad_perm:[3,3,3,3] row_mask:0xf bank_mask:0xf
    v_dot2c_f32_bf16_dpp v33, v92, v170 quad_perm:[3,3,3,3] row_mask:0xf bank_mask:0xf
    v_dot2c_f32_bf16_dpp v35, v92, v171 quad_perm:[3,3,3,3] row_mask:0xf bank_mask:0xf
    s_waitcnt vmcnt(7)
    buffer_load_dwordx4 v[172:175], v10, s[56:59], 0 offen offset:0 nt
    v_lshlrev_b32 v92, 16, v78
    v_dot2c_f32_bf16_dpp v28, v78, v188 quad_perm:[0,0,0,0] row_mask:0xf bank_mask:0xf
    v_dot2c_f32_bf16_dpp v30, v78, v189 quad_perm:[0,0,0,0] row_mask:0xf bank_mask:0xf
    v_dot2c_f32_bf16_dpp v32, v78, v190 quad_perm:[0,0,0,0] row_mask:0xf bank_mask:0xf
    v_dot2c_f32_bf16_dpp v34, v78, v191 quad_perm:[0,0,0,0] row_mask:0xf bank_mask:0xf
    v_dot2c_f32_bf16_dpp v29, v92, v188 quad_perm:[0,0,0,0] row_mask:0xf bank_mask:0xf
    v_dot2c_f32_bf16_dpp v31, v92, v189 quad_perm:[0,0,0,0] row_mask:0xf bank_mask:0xf
    v_dot2c_f32_bf16_dpp v33, v92, v190 quad_perm:[0,0,0,0] row_mask:0xf bank_mask:0xf
    v_dot2c_f32_bf16_dpp v35, v92, v191 quad_perm:[0,0,0,0] row_mask:0xf bank_mask:0xf
    v_mov_b32 v82, 100
    ds_write_b32 v95, v82 offset:2568
    s_waitcnt vmcnt(7)
    buffer_load_dwordx4 v[176:179], v10, s[56:59], s89 offen offset:0 nt
    v_dot2c_f32_bf16_dpp v28, v78, v192 quad_perm:[1,1,1,1] row_mask:0xf bank_mask:0xf
    v_dot2c_f32_bf16_dpp v30, v78, v193 quad_perm:[1,1,1,1] row_mask:0xf bank_mask:0xf
    v_dot2c_f32_bf16_dpp v32, v78, v194 quad_perm:[1,1,1,1] row_mask:0xf bank_mask:0xf
    v_dot2c_f32_bf16_dpp v34, v78, v195 quad_perm:[1,1,1,1] row_mask:0xf bank_mask:0xf
    v_dot2c_f32_bf16_dpp v29, v92, v192 quad_perm:[1,1,1,1] row_mask:0xf bank_mask:0xf
    v_dot2c_f32_bf16_dpp v31, v92, v193 quad_perm:[1,1,1,1] row_mask:0xf bank_mask:0xf
    v_dot2c_f32_bf16_dpp v33, v92, v194 quad_perm:[1,1,1,1] row_mask:0xf bank_mask:0xf
    v_dot2c_f32_bf16_dpp v35, v92, v195 quad_perm:[1,1,1,1] row_mask:0xf bank_mask:0xf
    v_fma_f32 v79, v67, s90, v72
    v_exp_f32 v79, v79
    s_nop 0
    v_cvt_pk_bf16_f32 v79, v79, 0
    s_waitcnt vmcnt(7)
    buffer_load_dwordx4 v[180:183], v10, s[56:59], 0 offen offset:896 nt
    v_dot2c_f32_bf16_dpp v28, v78, v196 quad_perm:[2,2,2,2] row_mask:0xf bank_mask:0xf
    v_dot2c_f32_bf16_dpp v30, v78, v197 quad_perm:[2,2,2,2] row_mask:0xf bank_mask:0xf
    v_dot2c_f32_bf16_dpp v32, v78, v198 quad_perm:[2,2,2,2] row_mask:0xf bank_mask:0xf
    v_dot2c_f32_bf16_dpp v34, v78, v199 quad_perm:[2,2,2,2] row_mask:0xf bank_mask:0xf
    v_dot2c_f32_bf16_dpp v29, v92, v196 quad_perm:[2,2,2,2] row_mask:0xf bank_mask:0xf
    v_dot2c_f32_bf16_dpp v31, v92, v197 quad_perm:[2,2,2,2] row_mask:0xf bank_mask:0xf
    v_dot2c_f32_bf16_dpp v33, v92, v198 quad_perm:[2,2,2,2] row_mask:0xf bank_mask:0xf
    v_dot2c_f32_bf16_dpp v35, v92, v199 quad_perm:[2,2,2,2] row_mask:0xf bank_mask:0xf
    s_waitcnt vmcnt(7)
    buffer_load_dwordx4 v[184:187], v10, s[56:59], s89 offen offset:896 nt
    v_dot2c_f32_bf16_dpp v28, v78, v200 quad_perm:[3,3,3,3] row_mask:0xf bank_mask:0xf
    v_dot2c_f32_bf16_dpp v30, v78, v201 quad_perm:[3,3,3,3] row_mask:0xf bank_mask:0xf
    v_dot2c_f32_bf16_dpp v32, v78, v202 quad_perm:[3,3,3,3] row_mask:0xf bank_mask:0xf
    v_dot2c_f32_bf16_dpp v34, v78, v203 quad_perm:[3,3,3,3] row_mask:0xf bank_mask:0xf
    v_dot2c_f32_bf16_dpp v29, v92, v200 quad_perm:[3,3,3,3] row_mask:0xf bank_mask:0xf
    v_dot2c_f32_bf16_dpp v31, v92, v201 quad_perm:[3,3,3,3] row_mask:0xf bank_mask:0xf
    v_dot2c_f32_bf16_dpp v33, v92, v202 quad_perm:[3,3,3,3] row_mask:0xf bank_mask:0xf
    v_dot2c_f32_bf16_dpp v35, v92, v203 quad_perm:[3,3,3,3] row_mask:0xf bank_mask:0xf
    v_lshlrev_b32 v92, 16, v79
    s_waitcnt vmcnt(7)
    v_dot2c_f32_bf16_dpp v28, v79, v204 quad_perm:[0,0,0,0] row_mask:0xf bank_mask:0xf
    v_dot2c_f32_bf16_dpp v30, v79, v205 quad_perm:[0,0,0,0] row_mask:0xf bank_mask:0xf
    v_dot2c_f32_bf16_dpp v32, v79, v206 quad_perm:[0,0,0,0] row_mask:0xf bank_mask:0xf
    v_dot2c_f32_bf16_dpp v34, v79, v207 quad_perm:[0,0,0,0] row_mask:0xf bank_mask:0xf
    v_dot2c_f32_bf16_dpp v29, v92, v204 quad_perm:[0,0,0,0] row_mask:0xf bank_mask:0xf
    v_dot2c_f32_bf16_dpp v31, v92, v205 quad_perm:[0,0,0,0] row_mask:0xf bank_mask:0xf
    v_dot2c_f32_bf16_dpp v33, v92, v206 quad_perm:[0,0,0,0] row_mask:0xf bank_mask:0xf
    v_dot2c_f32_bf16_dpp v35, v92, v207 quad_perm:[0,0,0,0] row_mask:0xf bank_mask:0xf
    s_waitcnt vmcnt(6)
    v_dot2c_f32_bf16_dpp v28, v79, v208 quad_perm:[1,1,1,1] row_mask:0xf bank_mask:0xf
    v_dot2c_f32_bf16_dpp v30, v79, v209 quad_perm:[1,1,1,1] row_mask:0xf bank_mask:0xf
    v_dot2c_f32_bf16_dpp v32, v79, v210 quad_perm:[1,1,1,1] row_mask:0xf bank_mask:0xf
    v_dot2c_f32_bf16_dpp v34, v79, v211 quad_perm:[1,1,1,1] row_mask:0xf bank_mask:0xf
    v_dot2c_f32_bf16_dpp v29, v92, v208 quad_perm:[1,1,1,1] row_mask:0xf bank_mask:0xf
    v_dot2c_f32_bf16_dpp v31, v92, v209 quad_perm:[1,1,1,1] row_mask:0xf bank_mask:0xf
    v_dot2c_f32_bf16_dpp v33, v92, v210 quad_perm:[1,1,1,1] row_mask:0xf bank_mask:0xf
    v_dot2c_f32_bf16_dpp v35, v92, v211 quad_perm:[1,1,1,1] row_mask:0xf bank_mask:0xf
    s_waitcnt vmcnt(5)
    v_dot2c_f32_bf16_dpp v28, v79, v212 quad_perm:[2,2,2,2] row_mask:0xf bank_mask:0xf
    v_dot2c_f32_bf16_dpp v30, v79, v213 quad_perm:[2,2,2,2] row_mask:0xf bank_mask:0xf
    v_dot2c_f32_bf16_dpp v32, v79, v214 quad_perm:[2,2,2,2] row_mask:0xf bank_mask:0xf
    v_dot2c_f32_bf16_dpp v34, v79, v215 quad_perm:[2,2,2,2] row_mask:0xf bank_mask:0xf
    v_dot2c_f32_bf16_dpp v29, v92, v212 quad_perm:[2,2,2,2] row_mask:0xf bank_mask:0xf
    v_dot2c_f32_bf16_dpp v31, v92, v213 quad_perm:[2,2,2,2] row_mask:0xf bank_mask:0xf
    v_dot2c_f32_bf16_dpp v33, v92, v214 quad_perm:[2,2,2,2] row_mask:0xf bank_mask:0xf
    v_dot2c_f32_bf16_dpp v35, v92, v215 quad_perm:[2,2,2,2] row_mask:0xf bank_mask:0xf
    s_waitcnt vmcnt(4)
    v_dot2c_f32_bf16_dpp v28, v79, v216 quad_perm:[3,3,3,3] row_mask:0xf bank_mask:0xf
    v_dot2c_f32_bf16_dpp v30, v79, v217 quad_perm:[3,3,3,3] row_mask:0xf bank_mask:0xf
    v_dot2c_f32_bf16_dpp v32, v79, v218 quad_perm:[3,3,3,3] row_mask:0xf bank_mask:0xf
    v_dot2c_f32_bf16_dpp v34, v79, v219 quad_perm:[3,3,3,3] row_mask:0xf bank_mask:0xf
    v_dot2c_f32_bf16_dpp v29, v92, v216 quad_perm:[3,3,3,3] row_mask:0xf bank_mask:0xf
    v_dot2c_f32_bf16_dpp v31, v92, v217 quad_perm:[3,3,3,3] row_mask:0xf bank_mask:0xf
    v_dot2c_f32_bf16_dpp v33, v92, v218 quad_perm:[3,3,3,3] row_mask:0xf bank_mask:0xf
    v_dot2c_f32_bf16_dpp v35, v92, v219 quad_perm:[3,3,3,3] row_mask:0xf bank_mask:0xf
    v_permlane32_swap_b32 v28, v32
    s_nop 0
    v_permlane32_swap_b32 v29, v33
    v_permlane32_swap_b32 v30, v34
    v_permlane32_swap_b32 v31, v35
    v_pk_add_f32 v[28:29], v[28:29], v[32:33]
    v_pk_add_f32 v[30:31], v[30:31], v[34:35]
    s_nop 1
    v_permlane16_swap_b32 v28, v30
    v_permlane16_swap_b32 v29, v31
    v_pk_add_f32 v[28:29], v[28:29], v[30:31]
    s_nop 1
    v_add_f32_dpp v29, v29, v29 row_ror:8 row_mask:0xf bank_mask:0xc
    s_nop 1
    v_add_f32_dpp v29, v28, v28 row_ror:8 row_mask:0xf bank_mask:0x3
    v_and_or_b32 v32, v29, s31, v94
    s_cmp_lg_u32 s1, 0
    s_cbranch_scc1 L_pglob
    buffer_store_dword v32, v11, s[60:63], s87 offen
    buffer_store_dword v68, v11, s[60:63], s87 offen offset:1024
    buffer_store_dword v69, v11, s[60:63], s87 offen offset:2048
L_pdone:
    s_waitcnt lgkmcnt(0)
    s_barrier
    s_cmp_eq_u32 s75, 7
    s_cbranch_scc1 L_nyA
    ds_read_b128 v[16:19], v99 offset:5184
L_gA:
    s_wqm_b64 exec, exec
    buffer_load_dwordx4 v[52:55], v12, s[60:63], s80 offen sc1
    buffer_load_dwordx4 v[56:59], v12, s[60:63], s17 offen sc1
    buffer_load_dwordx4 v[60:63], v12, s[60:63], s18 offen sc1
    buffer_load_dwordx4 v[64:67], v12, s[60:63], s19 offen sc1
    s_sub_u32 s91, s91, 1
    s_cmp_gt_i32 s91, 0
    s_cselect_b64 s[70:71], -1, 0
    s_waitcnt vmcnt(0)
    v_xor_b32 v52, s69, v52
    v_xor_b32 v53, s92, v53
    v_xor_b32 v54, s93, v54
    v_xor_b32 v55, s94, v55
    v_xor_b32 v56, s69, v56
    v_xor_b32 v57, s92, v57
    v_xor_b32 v58, s93, v58
    v_xor_b32 v59, s94, v59
    v_xor_b32 v60, s69, v60
    v_xor_b32 v61, s92, v61
    v_xor_b32 v62, s93, v62
    v_xor_b32 v63, s94, v63
    v_xor_b32 v64, s69, v64
    v_xor_b32 v65, s92, v65
    v_xor_b32 v66, s93, v66
    v_xor_b32 v67, s94, v67
    v_or3_b32 v2, v52, v53, v54
    v_or3_b32 v3, v55, v56, v57
    v_or3_b32 v2, v2, v58, v59
    v_or3_b32 v3, v3, v60, v61
    v_or3_b32 v2, v2, v62, v63
    v_or3_b32 v3, v3, v64, v65
    v_or3_b32 v2, v2, v66, v67
    v_bitop3_b32 v2, v2, v3, s31 bitop3:0x54
    v_cmp_ne_u32 vcc, 0, v2
    s_nop 1
    s_and_b64 exec, vcc, s[70:71]
    s_cbranch_scc1 L_gA
    s_mov_b64 exec, -1
    s_waitcnt lgkmcnt(0)
    v_pk_mul_f32 v[52:53], v[16:17], v[52:53] op_sel:[0,0] op_sel_hi:[0,1]
    v_pk_mul_f32 v[54:55], v[16:17], v[54:55] op_sel:[0,0] op_sel_hi:[0,1]
    v_pk_fma_f32 v[52:53], v[16:17], v[56:57], v[52:53] op_sel:[1,0,0] op_sel_hi:[1,1,1]
    v_pk_fma_f32 v[54:55], v[16:17], v[58:59], v[54:55] op_sel:[1,0,0] op_sel_hi:[1,1,1]
    v_pk_fma_f32 v[52:53], v[18:19], v[60:61], v[52:53] op_sel:[0,0,0] op_sel_hi:[0,1,1]
    v_pk_fma_f32 v[54:55], v[18:19], v[62:63], v[54:55] op_sel:[0,0,0] op_sel_hi:[0,1,1]
    v_pk_fma_f32 v[52:53], v[18:19], v[64:65], v[52:53] op_sel:[1,0,0] op_sel_hi:[1,1,1]
    v_pk_fma_f32 v[54:55], v[18:19], v[66:67], v[54:55] op_sel:[1,0,0] op_sel_hi:[1,1,1]
    s_nop 1
    v_permlane32_swap_b32 v52, v54
    v_permlane32_swap_b32 v53, v55
    v_pk_add_f32 v[52:53], v[52:53], v[54:55]
    s_nop 1
    v_permlane16_swap_b32 v52, v53
    v_add_f32 v52, v52, v53
    s_nop 1
    v_add_f32_dpp v52, v52, v52 row_ror:8 row_mask:0xf bank_mask:0xf
    s_nop 1
    v_mov_b32_dpp v52, v52 row_ror:4 row_mask:0xf bank_mask:0x6
    v_cvt_pk_bf16_f32 v20, v52, 0
    v_cvt_pk_bf16_f32 v21, 0, v52
    s_nop 0
    v_dot2c_f32_bf16_dpp v44, v20, v172 quad_perm:[0,0,0,0] row_mask:0xf bank_mask:0xf
    v_dot2c_f32_bf16_dpp v46, v20, v173 quad_perm:[0,0,0,0] row_mask:0xf bank_mask:0xf
    v_dot2c_f32_bf16_dpp v48, v20, v174 quad_perm:[0,0,0,0] row_mask:0xf bank_mask:0xf
    v_dot2c_f32_bf16_dpp v50, v20, v175 quad_perm:[0,0,0,0] row_mask:0xf bank_mask:0xf
    v_dot2c_f32_bf16_dpp v45, v21, v172 quad_perm:[0,0,0,0] row_mask:0xf bank_mask:0xf
    v_dot2c_f32_bf16_dpp v47, v21, v173 quad_perm:[0,0,0,0] row_mask:0xf bank_mask:0xf
    v_dot2c_f32_bf16_dpp v49, v21, v174 quad_perm:[0,0,0,0] row_mask:0xf bank_mask:0xf
    v_dot2c_f32_bf16_dpp v51, v21, v175 quad_perm:[0,0,0,0] row_mask:0xf bank_mask:0xf
    v_dot2c_f32_bf16_dpp v44, v20, v176 quad_perm:[1,1,1,1] row_mask:0xf bank_mask:0xf
    v_dot2c_f32_bf16_dpp v46, v20, v177 quad_perm:[1,1,1,1] row_mask:0xf bank_mask:0xf
    v_dot2c_f32_bf16_dpp v48, v20, v178 quad_perm:[1,1,1,1] row_mask:0xf bank_mask:0xf
    v_dot2c_f32_bf16_dpp v50, v20, v179 quad_perm:[1,1,1,1] row_mask:0xf bank_mask:0xf
    v_dot2c_f32_bf16_dpp v45, v21, v176 quad_perm:[1,1,1,1] row_mask:0xf bank_mask:0xf
    v_dot2c_f32_bf16_dpp v47, v21, v177 quad_perm:[1,1,1,1] row_mask:0xf bank_mask:0xf
    v_dot2c_f32_bf16_dpp v49, v21, v178 quad_perm:[1,1,1,1] row_mask:0xf bank_mask:0xf
    v_dot2c_f32_bf16_dpp v51, v21, v179 quad_perm:[1,1,1,1] row_mask:0xf bank_mask:0xf
    v_dot2c_f32_bf16_dpp v44, v20, v180 quad_perm:[2,2,2,2] row_mask:0xf bank_mask:0xf
    v_dot2c_f32_bf16_dpp v46, v20, v181 quad_perm:[2,2,2,2] row_mask:0xf bank_mask:0xf
    v_dot2c_f32_bf16_dpp v48, v20, v182 quad_perm:[2,2,2,2] row_mask:0xf bank_mask:0xf
    v_dot2c_f32_bf16_dpp v50, v20, v183 quad_perm:[2,2,2,2] row_mask:0xf bank_mask:0xf
    v_dot2c_f32_bf16_dpp v45, v21, v180 quad_perm:[2,2,2,2] row_mask:0xf bank_mask:0xf
    v_dot2c_f32_bf16_dpp v47, v21, v181 quad_perm:[2,2,2,2] row_mask:0xf bank_mask:0xf
    v_dot2c_f32_bf16_dpp v49, v21, v182 quad_perm:[2,2,2,2] row_mask:0xf bank_mask:0xf
    v_dot2c_f32_bf16_dpp v51, v21, v183 quad_perm:[2,2,2,2] row_mask:0xf bank_mask:0xf
    v_dot2c_f32_bf16_dpp v44, v20, v184 quad_perm:[3,3,3,3] row_mask:0xf bank_mask:0xf
    v_dot2c_f32_bf16_dpp v46, v20, v185 quad_perm:[3,3,3,3] row_mask:0xf bank_mask:0xf
    v_dot2c_f32_bf16_dpp v48, v20, v186 quad_perm:[3,3,3,3] row_mask:0xf bank_mask:0xf
    v_dot2c_f32_bf16_dpp v50, v20, v187 quad_perm:[3,3,3,3] row_mask:0xf bank_mask:0xf
    v_dot2c_f32_bf16_dpp v45, v21, v184 quad_perm:[3,3,3,3] row_mask:0xf bank_mask:0xf
    v_dot2c_f32_bf16_dpp v47, v21, v185 quad_perm:[3,3,3,3] row_mask:0xf bank_mask:0xf
    v_dot2c_f32_bf16_dpp v49, v21, v186 quad_perm:[3,3,3,3] row_mask:0xf bank_mask:0xf
    v_dot2c_f32_bf16_dpp v51, v21, v187 quad_perm:[3,3,3,3] row_mask:0xf bank_mask:0xf
    v_permlane32_swap_b32 v44, v48
    s_nop 0
    v_permlane32_swap_b32 v45, v49
    v_permlane32_swap_b32 v46, v50
    v_permlane32_swap_b32 v47, v51
    v_pk_add_f32 v[44:45], v[44:45], v[48:49]
    v_pk_add_f32 v[46:47], v[46:47], v[50:51]
    s_nop 1
    v_permlane16_swap_b32 v44, v46
    v_permlane16_swap_b32 v45, v47
    v_pk_add_f32 v[44:45], v[44:45], v[46:47]
    s_nop 1
    v_add_f32_dpp v45, v45, v45 row_ror:8 row_mask:0xf bank_mask:0xc
    s_nop 1
    v_add_f32_dpp v45, v44, v44 row_ror:8 row_mask:0xf bank_mask:0x3
    s_cmp_eq_u32 s3, 0
    s_cbranch_scc1 L_rA
    v_and_b32 v45, -2, v45
    ds_write_b32 v77, v45 offset:5376
    s_branch L_finA
L_rA:
    ds_read_b32 v46, v11 offset:5632
    ds_read_b32 v47, v11 offset:5888
    ds_read_b32 v48, v11 offset:6144
    s_sub_u32 s91, s91, 1
    s_cmp_gt_i32 s91, 0
    s_cselect_b64 s[70:71], -1, 0
    s_waitcnt lgkmcnt(0)
    v_max3_u32 v2, v46, v47, v48
    v_add_f32 v49, v45, v46
    v_add_f32 v50, v47, v48
    v_cmp_eq_u32 vcc, -1, v2
    v_add_f32 v49, v49, v50
    v_and_or_b32 v49, v49, s31, v94
    s_and_b64 vcc, vcc, s[70:71]
    s_cbranch_scc1 L_rA
    buffer_store_dword v49, v11, s[60:63], s88 offen sc1
L_nyA:
    s_or_b32 s9, s9, s3
    s_cbranch_scc1 L_finA
    s_waitcnt vmcnt(0)
L_fA:
    s_wqm_b64 exec, exec
    buffer_load_dwordx4 v[52:55], v13, s[60:63], s10 offen sc1
    s_sub_u32 s91, s91, 1
    s_cmp_gt_i32 s91, 0
    s_cselect_b64 s[70:71], -1, 0
    s_waitcnt vmcnt(0)
    v_xor_b32 v52, s69, v52
    v_xor_b32 v53, s92, v53
    v_xor_b32 v54, s93, v54
    v_xor_b32 v55, s94, v55
    v_or3_b32 v2, v52, v53, v54
    v_bitop3_b32 v2, v2, v55, s31 bitop3:0x54
    v_cmp_ne_u32 vcc, 0, v2
    s_nop 1
    s_and_b64 exec, vcc, s[70:71]
    s_cbranch_scc1 L_fA
    s_mov_b64 exec, -1
    s_nop 0
    v_permlane32_swap_b32 v52, v54
    v_permlane32_swap_b32 v53, v55
    v_pk_add_f32 v[52:53], v[52:53], v[54:55]
    s_nop 1
    v_permlane16_swap_b32 v52, v53
    v_add_f32 v52, v52, v53
    s_nop 1
    v_add_f32_dpp v52, v52, v52 row_ror:8 row_mask:0xf bank_mask:0xf
    s_nop 1
    v_add_f32_dpp v52, v52, v52 row_ror:4 row_mask:0xf bank_mask:0xf
    s_nop 1
    v_add_f32_dpp v52, v52, v52 quad_perm:[2,3,0,1] row_mask:0xf bank_mask:0xf
    v_cvt_pk_bf16_f32 v4, v52, 0
    s_mov_b64 exec, s[14:15]
    buffer_store_short v4, v76, s[64:67], s12 offen
    s_cmp_lg_u32 s0, 128
    s_cbranch_scc1 L_finA
    s_mov_b64 exec, 1
    v_mov_b32 v4, s30
    buffer_store_dword v4, v0, s[60:63], 0 offen
L_finA:
    s_endpgm
L_pglob:
    buffer_store_dword v32, v11, s[60:63], s87 offen sc1
    buffer_store_dword v68, v11, s[60:63], s87 offen offset:1024 sc1
    buffer_store_dword v69, v11, s[60:63], s87 offen offset:2048 sc1
    s_branch L_pdone
.p2align 6
L_hprog:
    v_mov_b32 v28, 0
    v_mov_b32 v29, 0
    v_mov_b32 v30, 0
    v_mov_b32 v31, 0
    ds_write_b128 v28, v[28:31] offset:2560
    v_mov_b32 v2, -1
    v_mov_b32 v3, -1
    s_lshl_b32 s77, s3, 9
    v_lshl_add_u32 v4, v0, 3, s77
    ds_write_b64 v4, v[2:3] offset:5376
    s_bfe_u32 s82, s2, 0x10004
    s_add_u32 s74, s2, s72
    s_add_u32 s74, s74, s82
    s_and_b32 s74, s74, 7
    s_bfe_u32 s73, s2, 0x10003
    s_waitcnt lgkmcnt(0)
    s_load_dword s30, s[28:29], 0
    s_mov_b32 s60, s28
    s_mov_b32 s61, s29
    s_mov_b32 s62, 2097152
    s_mov_b32 s63, 0x20000
    s_mov_b32 s90, 0x3db8aa3b
    s_mov_b32 s91, 4000000
    s_mov_b32 s31, 0xffffff00
    v_lshlrev_b32 v11, 2, v0
    v_mov_b32 v95, 0
    v_mov_b32 v98, 1
    v_lshrrev_b32 v2, 3, v0
    v_and_b32 v3, 3, v0
    v_xor_b32 v3, s3, v3
    v_lshl_add_u32 v2, v2, 2, v3
    v_mul_u32_u24 v97, 80, v2
    s_and_b32 s75, s2, 7
    s_bfe_u32 s76, s2, 0x10003
    s_mov_b32 s95, 0x3f803f80
    s_lshl_b32 s77, s72, 13
    s_add_u32 s77, s77, 4096
    s_lshr_b32 s78, s74, 2
    s_lshl1_add_u32 s78, s82, s78
    s_lshl1_add_u32 s78, s78, s73
    s_and_b32 s79, s74, 3
    s_lshl2_add_u32 s78, s78, s79
    s_lshl_b32 s78, s78, 8
    s_add_u32 s85, s77, s78
    s_add_u32 s78, s82, 2
    s_sub_u32 s79, s3, 1
    s_cmp_eq_u32 s3, 0
    s_cselect_b32 s79, s78, s79
    s_xor_b32 s78, s78, 1
    s_cmp_eq_u32 s3, 3
    s_cselect_b32 s78, s78, s79
    s_lshl_b32 s78, s78, 11
    s_add_u32 s84, s77, s78
    s_getreg_b32 s1, hwreg(HW_REG_XCC_ID, 0, 3)
    s_lshl_b32 s1, s1, 8
    s_mul_i32 s87, s2, 3200
    s_add_u32 s87, s87, 69632
    v_lshrrev_b32 v2, 3, v0
    v_and_b32 v3, 7, v0
    v_lshlrev_b32 v99, 3, v2
    v_mul_u32_u24 v12, 3200, v2
    v_lshl_add_u32 v12, v3, 4, v12
    v_lshrrev_b32 v4, 4, v0
    v_and_b32 v2, 1, v2
    v_lshl_add_u32 v2, v4, 2, v2
    v_mul_u32_u24 v10, 1792, v2
    v_lshl_add_u32 v10, v3, 4, v10
    v_lshrrev_b32 v2, 1, v0
    v_and_b32 v3, 1, v0
    v_mul_u32_u24 v13, 1920, v2
    v_lshl_add_u32 v13, v3, 4, v13
    v_lshlrev_b32 v3, 6, v3
    v_lshl_add_u32 v76, v4, 4, v3
    s_lshl2_add_u32 s83, s76, s3
    s_lshr_b32 s77, s2, 4
    s_lshl_b32 s78, s77, 8
    s_lshr_b32 s79, s83, 1
    s_lshl_b32 s79, s79, 6
    s_add_u32 s78, s78, s79
    s_and_b32 s79, s83, 1
    s_lshl2_add_u32 s78, s79, s78
    s_mulk_i32 s78, 896
    s_lshl_b32 s79, s75, 7
    s_add_u32 s78, s78, s79
    s_add_u32 s56, s22, s78
    s_addc_u32 s57, s23, 0
    s_cmp_eq_u32 s75, 7
    s_cselect_b32 s58, 0, 52992
    s_mov_b32 s59, 0x20000
    s_mov_b32 s89, 28672
    s_mov_b32 s64, s24
    s_mov_b32 s65, s25
    s_mov_b32 s66, 1792
    s_mov_b32 s67, 0x20000
    s_lshr_b32 s78, s2, 3
    s_mulk_i32 s78, 1920
    s_lshl_b32 s79, s75, 8
    s_add_u32 s78, s78, s79
    s_add_u32 s88, s78, 1110016
    s_lshl_b32 s79, s83, 7
    s_mul_i32 s80, s77, 51200
    s_add_u32 s80, s80, s79
    s_add_u32 s80, s80, 69632
    s_add_u32 s17, s80, 25600
    s_and_b32 s0, s2, 31
    s_lshl3_add_u32 s0, s0, s72
    s_lshl_b32 s10, s72, 8
    s_lshl_b32 s11, s75, 5
    s_add_u32 s10, s10, s11
    s_add_u32 s10, s10, 1110016
    s_lshl_b32 s12, s72, 6
    s_add_u32 s12, s12, s75
    s_lshl_b32 s12, s12, 1
    s_add_u32 s12, s12, 896
    s_mov_b32 s14, 0x00030003
    s_mov_b32 s15, 0x00030003
    s_bfe_u32 s9, s2, 0x20003
    s_cmp_eq_u32 s72, 7
    s_cselect_b32 s9, 1, s9
    s_lshl_b32 s13, s3, 8
    v_add_u32 v77, s13, v11
    v_mov_b32 v44, 0
    v_mov_b32 v45, 0
    v_mov_b32 v46, 0
    v_mov_b32 v47, 0
    v_mov_b32 v48, 0
    v_mov_b32 v49, 0
    v_mov_b32 v50, 0
    v_mov_b32 v51, 0
    v_mov_b32 v75, 0
    v_mov_b32 v120, 0
    v_mov_b32 v121, 0
    s_waitcnt lgkmcnt(0)
    s_add_u32 s30, s30, 0x6A09E667
    s_bfe_u32 s69, s30, 0x80000
    s_bfe_u32 s92, s30, 0x80008
    s_bfe_u32 s93, s30, 0x80010
    s_bfe_u32 s94, s30, 0x80018
    v_and_b32 v2, 3, v0
    v_lshlrev_b32 v2, 3, v2
    v_mov_b32 v3, s30
    v_bfe_u32 v94, v3, v2, 8
    s_barrier
    s_cmp_lg_u32 s3, 3
    s_nop 2
    s_cbranch_scc1 L_qget
    ds_read_b32 v28, v11 offset:4160
    ds_read_b32 v29, v11 offset:4416
    ds_read_b32 v30, v11 offset:4672
    ds_read_b32 v31, v11 offset:4928
    s_waitcnt lgkmcnt(0)
    v_pk_add_f32 v[28:29], v[28:29], v[30:31]
    v_add_f32 v28, v28, v29
    v_and_b32 v28, 0xfffff800, v28
    v_or3_b32 v28, v28, s1, v94
    buffer_store_dword v28, v11, s[60:63], s85 offen sc1
    s_nop 3
L_qget:
L_wq:
    ds_read_b32 v2, v95 offset:2572
    s_sub_u32 s91, s91, 1
    s_waitcnt lgkmcnt(0)
    v_cmp_ne_u32 vcc, 1, v2
    s_nop 4
    s_cbranch_vccz L_wq_ok
    s_sleep 2
    s_cmp_gt_i32 s91, 0
    s_cbranch_scc1 L_wq
L_wq_ok:
    s_branch L_q_go
L_q:
    s_sleep 8
L_q_go:
    s_wqm_b64 exec, exec
    buffer_load_dwordx4 v[28:31], v1, s[60:63], s84 offen offset:0 sc1
    buffer_load_dwordx4 v[32:35], v1, s[60:63], s84 offen offset:1024 sc1
    s_sub_u32 s91, s91, 1
    s_cmp_gt_i32 s91, 0
    s_cselect_b64 s[70:71], -1, 0
    s_waitcnt vmcnt(0)
    v_xor_b32 v28, s69, v28
    v_xor_b32 v29, s92, v29
    v_xor_b32 v30, s93, v30
    v_xor_b32 v31, s94, v31
    v_xor_b32 v32, s69, v32
    v_xor_b32 v33, s92, v33
    v_xor_b32 v34, s93, v34
    v_xor_b32 v35, s94, v35
    v_or3_b32 v2, v28, v29, v30
    v_or3_b32 v3, v31, v32, v33
    v_or3_b32 v2, v2, v34, v35
    v_bitop3_b32 v2, v2, v3, s31 bitop3:0x54
    v_cmp_ne_u32 vcc, 0, v2
    s_nop 1
    s_and_b64 exec, vcc, s[70:71]
    s_cbranch_scc1 L_q
    s_mov_b64 exec, -1
    v_xor_b32 v2, s1, v28
    v_bitop3_b32 v2, v32, s1, v2 bitop3:0xbe
    v_and_b32 v2, 0x700, v2
    ds_or_b32 v95, v2 offset:2564
    s_cmp_eq_u32 s3, 3
    s_cbranch_scc1 L_qdone
    v_and_b32 v28, 0xfffff800, v28
    v_and_b32 v29, 0xfffff800, v29
    v_and_b32 v30, 0xfffff800, v30
    v_and_b32 v31, 0xfffff800, v31
    v_and_b32 v32, 0xfffff800, v32
    v_and_b32 v33, 0xfffff800, v33
    v_and_b32 v34, 0xfffff800, v34
    v_and_b32 v35, 0xfffff800, v35
    v_pk_add_f32 v[28:29], v[28:29], v[32:33]
    v_pk_add_f32 v[30:31], v[30:31], v[34:35]
    v_cvt_pk_bf16_f32 v4, v28, v29
    v_cvt_pk_bf16_f32 v5, v30, v31
    s_lshl_b32 s77, s3, 9
    v_lshl_add_u32 v2, v0, 3, s77
    ds_write_b64 v2, v[4:5] offset:2624
    s_mov_b64 exec, 1
    ds_add_u32 v95, v98 offset:2560
    s_mov_b64 exec, -1
    s_nop 0
L_qdone:
    s_waitcnt lgkmcnt(0)
    s_barrier
    s_cmp_lg_u32 s3, 3
    s_cbranch_scc1 L_mldone
    ds_read_b128 v[52:55], v97 offset:0
    ds_read_b128 v[56:59], v97 offset:16
    ds_read_b128 v[60:63], v97 offset:32
    ds_read_b128 v[64:67], v97 offset:48
    ds_read_b128 v[68:71], v97 offset:64
    ds_read_b32 v3, v95 offset:2564
    s_waitcnt lgkmcnt(0)
    v_readfirstlane_b32 s1, v3
    v_max_f32 v73, v68, v69
    v_max_f32 v74, v70, v71
    v_max3_f32 v72, v52, v53, v54
    v_max3_f32 v2, v55, v56, v57
    v_max3_f32 v72, v72, v58, v59
    v_max3_f32 v2, v2, v60, v61
    v_max3_f32 v72, v72, v62, v63
    v_max3_f32 v2, v2, v64, v65
    v_max3_f32 v72, v72, v66, v67
    v_max_f32 v72, v72, v2
    v_max_f32_dpp v73, v73, v73 quad_perm:[1,0,3,2] row_mask:0xf bank_mask:0xf
    v_max_f32_dpp v74, v74, v74 quad_perm:[1,0,3,2] row_mask:0xf bank_mask:0xf
    v_max_f32_dpp v72, v72, v72 quad_perm:[1,0,3,2] row_mask:0xf bank_mask:0xf
    v_max_f32_dpp v73, v73, v73 quad_perm:[2,3,0,1] row_mask:0xf bank_mask:0xf
    v_max_f32_dpp v74, v74, v74 quad_perm:[2,3,0,1] row_mask:0xf bank_mask:0xf
    v_max_f32_dpp v72, v72, v72 quad_perm:[2,3,0,1] row_mask:0xf bank_mask:0xf
    v_max_f32_dpp v73, v73, v73 row_ror:8 row_mask:0xf bank_mask:0xf
    v_max_f32_dpp v74, v74, v74 row_ror:8 row_mask:0xf bank_mask:0xf
    v_max_f32_dpp v72, v72, v72 row_ror:8 row_mask:0xf bank_mask:0xf
    v_mov_b32 v78, v73
    v_mov_b32 v79, v74
    v_mov_b32 v80, v72
    v_permlane16_swap_b32 v78, v73
    v_permlane16_swap_b32 v79, v74
    v_permlane16_swap_b32 v80, v72
    v_max_f32 v73, v73, v78
    v_max_f32 v74, v74, v79
    v_max_f32 v72, v72, v80
    v_mov_b32 v78, v73
    v_mov_b32 v79, v74
    v_mov_b32 v80, v72
    v_permlane32_swap_b32 v78, v73
    v_permlane32_swap_b32 v79, v74
    v_permlane32_swap_b32 v80, v72
    v_max_f32 v73, v73, v78
    v_max_f32 v74, v74, v79
    v_max_f32 v72, v72, v80
    v_mul_f32_e64 v73, s90, -v73
    v_mul_f32_e64 v74, s90, -v74
    v_mul_f32_e64 v72, s90, -v72
    v_fma_f32 v68, v68, s90, v73
    v_fma_f32 v70, v70, s90, v74
    v_fma_f32 v69, v69, s90, v73
    v_fma_f32 v71, v71, s90, v74
    v_exp_f32 v68, v68
    v_exp_f32 v70, v70
    v_exp_f32 v69, v69
    v_exp_f32 v71, v71
    v_cvt_pk_bf16_f32 v68, v68, 0
    v_cvt_pk_bf16_f32 v70, v70, 0
    v_cvt_pk_bf16_f32 v69, v69, 0
    v_cvt_pk_bf16_f32 v71, v71, 0
    v_dot2c_f32_bf16 v120, s95, v68
    v_dot2c_f32_bf16 v121, s95, v70
    v_dot2c_f32_bf16 v120, s95, v69
    v_dot2c_f32_bf16 v121, s95, v71
    v_fma_f32 v52, v52, s90, v72
    v_fma_f32 v53, v53, s90, v72
    v_fma_f32 v54, v54, s90, v72
    v_fma_f32 v55, v55, s90, v72
    v_exp_f32 v52, v52
    v_exp_f32 v53, v53
    v_exp_f32 v54, v54
    v_exp_f32 v55, v55
    v_cvt_pk_bf16_f32 v52, v52, 0
    v_cvt_pk_bf16_f32 v53, v53, 0
    v_cvt_pk_bf16_f32 v54, v54, 0
    v_cvt_pk_bf16_f32 v55, v55, 0
    v_dot2c_f32_bf16 v75, s95, v52
    v_dot2c_f32_bf16 v75, s95, v53
    v_dot2c_f32_bf16 v75, s95, v54
    v_dot2c_f32_bf16 v75, s95, v55
    v_fma_f32 v56, v56, s90, v72
    v_fma_f32 v57, v57, s90, v72
    v_fma_f32 v58, v58, s90, v72
    v_fma_f32 v59, v59, s90, v72
    v_exp_f32 v56, v56
    v_exp_f32 v57, v57
    v_exp_f32 v58, v58
    v_exp_f32 v59, v59
    v_cvt_pk_bf16_f32 v56, v56, 0
    v_cvt_pk_bf16_f32 v57, v57, 0
    v_cvt_pk_bf16_f32 v58, v58, 0
    v_cvt_pk_bf16_f32 v59, v59, 0
    v_dot2c_f32_bf16 v75, s95, v56
    v_dot2c_f32_bf16 v75, s95, v57
    v_dot2c_f32_bf16 v75, s95, v58
    v_dot2c_f32_bf16 v75, s95, v59
    v_fma_f32 v60, v60, s90, v72
    v_fma_f32 v61, v61, s90, v72
    v_fma_f32 v62, v62, s90, v72
    v_fma_f32 v63, v63, s90, v72
    v_exp_f32 v60, v60
    v_exp_f32 v61, v61
    v_exp_f32 v62, v62
    v_exp_f32 v63, v63
    v_cvt_pk_bf16_f32 v60, v60, 0
    v_cvt_pk_bf16_f32 v61, v61, 0
    v_cvt_pk_bf16_f32 v62, v62, 0
    v_cvt_pk_bf16_f32 v63, v63, 0
    v_dot2c_f32_bf16 v75, s95, v60
    v_dot2c_f32_bf16 v75, s95, v61
    v_dot2c_f32_bf16 v75, s95, v62
    v_dot2c_f32_bf16 v75, s95, v63
    v_fma_f32 v64, v64, s90, v72
    v_fma_f32 v65, v65, s90, v72
    v_fma_f32 v66, v66, s90, v72
    v_fma_f32 v67, v67, s90, v72
    v_exp_f32 v64, v64
    v_exp_f32 v65, v65
    v_exp_f32 v66, v66
    v_exp_f32 v67, v67
    v_cvt_pk_bf16_f32 v64, v64, 0
    v_cvt_pk_bf16_f32 v65, v65, 0
    v_cvt_pk_bf16_f32 v66, v66, 0
    v_cvt_pk_bf16_f32 v67, v67, 0
    v_dot2c_f32_bf16 v75, s95, v64
    v_dot2c_f32_bf16 v75, s95, v65
    v_dot2c_f32_bf16 v75, s95, v66
    v_dot2c_f32_bf16 v75, s95, v67
    s_nop 2
    v_add_f32_dpp v75, v75, v75 quad_perm:[1,0,3,2] row_mask:0xf bank_mask:0xf
    v_add_f32_dpp v120, v120, v120 quad_perm:[1,0,3,2] row_mask:0xf bank_mask:0xf
    v_add_f32_dpp v121, v121, v121 quad_perm:[1,0,3,2] row_mask:0xf bank_mask:0xf
    v_add_f32_dpp v75, v75, v75 quad_perm:[2,3,0,1] row_mask:0xf bank_mask:0xf
    v_add_f32_dpp v120, v120, v120 quad_perm:[2,3,0,1] row_mask:0xf bank_mask:0xf
    v_add_f32_dpp v121, v121, v121 quad_perm:[2,3,0,1] row_mask:0xf bank_mask:0xf
    v_add_f32_dpp v75, v75, v75 row_ror:8 row_mask:0xf bank_mask:0xf
    v_add_f32_dpp v120, v120, v120 row_ror:8 row_mask:0xf bank_mask:0xf
    v_add_f32_dpp v121, v121, v121 row_ror:8 row_mask:0xf bank_mask:0xf
    v_mov_b32 v78, v75
    v_mov_b32 v79, v120
    v_mov_b32 v80, v121
    v_permlane16_swap_b32 v78, v75
    v_permlane16_swap_b32 v79, v120
    v_permlane16_swap_b32 v80, v121
    v_add_f32 v75, v75, v78
    v_add_f32 v120, v120, v79
    v_add_f32 v121, v121, v80
    v_mov_b32 v78, v75
    v_mov_b32 v79, v120
    v_mov_b32 v80, v121
    v_permlane32_swap_b32 v78, v75
    v_permlane32_swap_b32 v79, v120
    v_permlane32_swap_b32 v80, v121
    v_add_f32 v75, v75, v78
    v_add_f32 v120, v120, v79
    v_add_f32 v121, v121, v80
    v_cmp_eq_u32 vcc, 1, v0
    v_cmp_eq_u32 s[78:79], 2, v0
    s_nop 0
    v_cndmask_b32 v80, v72, v73, vcc
    v_cndmask_b32 v81, v75, v120, vcc
    v_cndmask_b32 v80, v80, v74, s[78:79]
    v_cndmask_b32 v81, v81, v121, s[78:79]
    v_mov_b32 v82, s30
    v_mov_b32 v83, s30
    s_mov_b64 exec, 0xff
    s_cmp_lg_u32 s1, 0
    s_cbranch_scc1 L_mg
    buffer_store_dwordx4 v[80:83], v1, s[60:63], s87 offen offset:3072
    s_branch L_mj
L_mg:
    buffer_store_dwordx4 v[80:83], v1, s[60:63], s87 offen offset:3072 sc1
L_mj:
    s_mov_b64 exec, -1
    v_and_b32 v2, 15, v0
    s_lshl_b32 s77, s82, 4
    v_add_u32 v2, s77, v2
    v_mul_u32_u24 v2, 3200, v2
    v_mul_u32_u24 v3, 3200, v0
    s_add_u32 s77, s77, 16
    v_add_u32 v3, s77, v3
    v_cmp_gt_u32 vcc, 32, v0
    s_nop 1
    v_cndmask_b32 v5, v2, v3, vcc
    s_mul_i32 s81, s72, 102400
    s_add_u32 s81, s81, 69632
    v_and_b32 v2, 7, v0
    v_lshrrev_b32 v3, 3, v0
    v_lshlrev_b32 v4, 4, v2
    v_lshl_add_u32 v4, v3, 2, v4
    v_and_b32 v3, 1, v3
    v_lshlrev_b32 v2, 3, v2
    v_lshl_add_u32 v2, v3, 2, v2
    v_add_u32 v2, 128, v2
    v_cndmask_b32 v92, v2, v4, vcc
    v_mov_b32 v93, 1.0
    v_cndmask_b32 v93, 2.0, v93, vcc
    s_mov_b32 s78, s30
    s_mov_b32 s79, s30
    s_nop 2
L_wg:
    ds_read_b32 v2, v95 offset:2568
    s_sub_u32 s91, s91, 1
    s_waitcnt lgkmcnt(0)
    v_cmp_gt_u32 vcc, 5, v2
    s_nop 4
    s_cbranch_vccz L_wg_ok
    s_sleep 4
    s_cmp_gt_i32 s91, 0
    s_cbranch_scc1 L_wg
L_wg_ok:
    s_branch L_m_go
L_m:
    s_sleep 8
L_m_go:
    s_wqm_b64 exec, exec
    buffer_load_dwordx4 v[28:31], v5, s[60:63], s81 offen offset:3072 sc1
    s_sub_u32 s91, s91, 1
    s_cmp_gt_i32 s91, 0
    s_cselect_b64 s[70:71], -1, 0
    s_waitcnt vmcnt(0)
    v_cmp_ne_u64 vcc, s[78:79], v[30:31]
    s_nop 1
    s_and_b64 exec, vcc, s[70:71]
    s_cbranch_scc1 L_m
    s_mov_b64 exec, -1
    v_mov_b32 v2, v28
    s_nop 1
    v_min_f32_dpp v2, v2, v2 quad_perm:[1,0,3,2] row_mask:0xf bank_mask:0xf
    s_nop 1
    v_min_f32_dpp v2, v2, v2 quad_perm:[2,3,0,1] row_mask:0xf bank_mask:0xf
    s_nop 1
    v_min_f32_dpp v2, v2, v2 row_ror:8 row_mask:0xf bank_mask:0xf
    s_nop 1
    v_min_f32_dpp v2, v2, v2 row_ror:4 row_mask:0xf bank_mask:0xf
    v_mov_b32 v4, v2
    s_nop 1
    v_permlane16_swap_b32 v4, v2
    v_min_f32 v2, v2, v4
    v_sub_f32 v28, v2, v28
    v_exp_f32 v28, v28
    s_nop 0
    v_mul_f32 v2, v28, v29
    s_nop 1
    v_add_f32_dpp v2, v2, v2 quad_perm:[1,0,3,2] row_mask:0xf bank_mask:0xf
    s_nop 1
    v_add_f32_dpp v2, v2, v2 quad_perm:[2,3,0,1] row_mask:0xf bank_mask:0xf
    s_nop 1
    v_add_f32_dpp v2, v2, v2 row_ror:8 row_mask:0xf bank_mask:0xf
    s_nop 1
    v_add_f32_dpp v2, v2, v2 row_ror:4 row_mask:0xf bank_mask:0xf
    v_mov_b32 v4, v2
    s_nop 1
    v_permlane16_swap_b32 v4, v2
    v_add_f32 v2, v2, v4
    v_rcp_f32 v2, v2
    v_mul_f32 v28, v93, v28
    v_mul_f32 v2, v2, v28
    ds_write_b32 v92, v2 offset:5184
    s_nop 3
L_mldone:
L_ww:
    ds_read_b32 v2, v95 offset:2568
    s_sub_u32 s91, s91, 1
    s_waitcnt lgkmcnt(0)
    v_cmp_gt_u32 vcc, 100, v2
    s_nop 4
    s_cbranch_vccz L_ww_ok
    s_sleep 2
    s_cmp_gt_i32 s91, 0
    s_cbranch_scc1 L_ww
L_ww_ok:
    buffer_load_dwordx4 v[100:103], v10, s[56:59], 0 offen offset:0 nt
    buffer_load_dwordx4 v[104:107], v10, s[56:59], s89 offen offset:0 nt
    buffer_load_dwordx4 v[108:111], v10, s[56:59], 0 offen offset:896 nt
    buffer_load_dwordx4 v[112:115], v10, s[56:59], s89 offen offset:896 nt
    s_barrier
    s_cmp_eq_u32 s75, 7
    s_cbranch_scc1 L_nyB
    ds_read_b64 v[16:17], v99 offset:5312
L_gB:
    s_wqm_b64 exec, exec
    buffer_load_dwordx4 v[52:55], v12, s[60:63], s80 offen sc1
    buffer_load_dwordx4 v[56:59], v12, s[60:63], s17 offen sc1
    s_sub_u32 s91, s91, 1
    s_cmp_gt_i32 s91, 0
    s_cselect_b64 s[70:71], -1, 0
    s_waitcnt vmcnt(0)
    v_xor_b32 v52, s69, v52
    v_xor_b32 v53, s92, v53
    v_xor_b32 v54, s93, v54
    v_xor_b32 v55, s94, v55
    v_xor_b32 v56, s69, v56
    v_xor_b32 v57, s92, v57
    v_xor_b32 v58, s93, v58
    v_xor_b32 v59, s94, v59
    v_or3_b32 v2, v52, v53, v54
    v_or3_b32 v3, v55, v56, v57
    v_or3_b32 v2, v2, v58, v59
    v_bitop3_b32 v2, v2, v3, s31 bitop3:0x54
    v_cmp_ne_u32 vcc, 0, v2
    s_nop 1
    s_and_b64 exec, vcc, s[70:71]
    s_cbranch_scc1 L_gB
    s_mov_b64 exec, -1
    s_waitcnt lgkmcnt(0)
    v_pk_mul_f32 v[52:53], v[16:17], v[52:53] op_sel:[0,0] op_sel_hi:[0,1]
    v_pk_mul_f32 v[54:55], v[16:17], v[54:55] op_sel:[0,0] op_sel_hi:[0,1]
    v_pk_fma_f32 v[52:53], v[16:17], v[56:57], v[52:53] op_sel:[1,0,0] op_sel_hi:[1,1,1]
    v_pk_fma_f32 v[54:55], v[16:17], v[58:59], v[54:55] op_sel:[1,0,0] op_sel_hi:[1,1,1]
    s_nop 1
    v_permlane32_swap_b32 v52, v54
    v_permlane32_swap_b32 v53, v55
    v_pk_add_f32 v[52:53], v[52:53], v[54:55]
    s_nop 1
    v_permlane16_swap_b32 v52, v53
    v_add_f32 v52, v52, v53
    s_nop 1
    v_add_f32_dpp v52, v52, v52 row_ror:8 row_mask:0xf bank_mask:0xf
    s_nop 1
    v_mov_b32_dpp v52, v52 row_ror:4 row_mask:0xf bank_mask:0x6
    v_cvt_pk_bf16_f32 v20, v52, 0
    v_cvt_pk_bf16_f32 v21, 0, v52
    s_nop 0
    v_dot2c_f32_bf16_dpp v44, v20, v100 quad_perm:[0,0,0,0] row_mask:0xf bank_mask:0xf
    v_dot2c_f32_bf16_dpp v46, v20, v101 quad_perm:[0,0,0,0] row_mask:0xf bank_mask:0xf
    v_dot2c_f32_bf16_dpp v48, v20, v102 quad_perm:[0,0,0,0] row_mask:0xf bank_mask:0xf
    v_dot2c_f32_bf16_dpp v50, v20, v103 quad_perm:[0,0,0,0] row_mask:0xf bank_mask:0xf
    v_dot2c_f32_bf16_dpp v45, v21, v100 quad_perm:[0,0,0,0] row_mask:0xf bank_mask:0xf
    v_dot2c_f32_bf16_dpp v47, v21, v101 quad_perm:[0,0,0,0] row_mask:0xf bank_mask:0xf
    v_dot2c_f32_bf16_dpp v49, v21, v102 quad_perm:[0,0,0,0] row_mask:0xf bank_mask:0xf
    v_dot2c_f32_bf16_dpp v51, v21, v103 quad_perm:[0,0,0,0] row_mask:0xf bank_mask:0xf
    v_dot2c_f32_bf16_dpp v44, v20, v104 quad_perm:[1,1,1,1] row_mask:0xf bank_mask:0xf
    v_dot2c_f32_bf16_dpp v46, v20, v105 quad_perm:[1,1,1,1] row_mask:0xf bank_mask:0xf
    v_dot2c_f32_bf16_dpp v48, v20, v106 quad_perm:[1,1,1,1] row_mask:0xf bank_mask:0xf
    v_dot2c_f32_bf16_dpp v50, v20, v107 quad_perm:[1,1,1,1] row_mask:0xf bank_mask:0xf
    v_dot2c_f32_bf16_dpp v45, v21, v104 quad_perm:[1,1,1,1] row_mask:0xf bank_mask:0xf
    v_dot2c_f32_bf16_dpp v47, v21, v105 quad_perm:[1,1,1,1] row_mask:0xf bank_mask:0xf
    v_dot2c_f32_bf16_dpp v49, v21, v106 quad_perm:[1,1,1,1] row_mask:0xf bank_mask:0xf
    v_dot2c_f32_bf16_dpp v51, v21, v107 quad_perm:[1,1,1,1] row_mask:0xf bank_mask:0xf
    v_dot2c_f32_bf16_dpp v44, v20, v108 quad_perm:[2,2,2,2] row_mask:0xf bank_mask:0xf
    v_dot2c_f32_bf16_dpp v46, v20, v109 quad_perm:[2,2,2,2] row_mask:0xf bank_mask:0xf
    v_dot2c_f32_bf16_dpp v48, v20, v110 quad_perm:[2,2,2,2] row_mask:0xf bank_mask:0xf
    v_dot2c_f32_bf16_dpp v50, v20, v111 quad_perm:[2,2,2,2] row_mask:0xf bank_mask:0xf
    v_dot2c_f32_bf16_dpp v45, v21, v108 quad_perm:[2,2,2,2] row_mask:0xf bank_mask:0xf
    v_dot2c_f32_bf16_dpp v47, v21, v109 quad_perm:[2,2,2,2] row_mask:0xf bank_mask:0xf
    v_dot2c_f32_bf16_dpp v49, v21, v110 quad_perm:[2,2,2,2] row_mask:0xf bank_mask:0xf
    v_dot2c_f32_bf16_dpp v51, v21, v111 quad_perm:[2,2,2,2] row_mask:0xf bank_mask:0xf
    v_dot2c_f32_bf16_dpp v44, v20, v112 quad_perm:[3,3,3,3] row_mask:0xf bank_mask:0xf
    v_dot2c_f32_bf16_dpp v46, v20, v113 quad_perm:[3,3,3,3] row_mask:0xf bank_mask:0xf
    v_dot2c_f32_bf16_dpp v48, v20, v114 quad_perm:[3,3,3,3] row_mask:0xf bank_mask:0xf
    v_dot2c_f32_bf16_dpp v50, v20, v115 quad_perm:[3,3,3,3] row_mask:0xf bank_mask:0xf
    v_dot2c_f32_bf16_dpp v45, v21, v112 quad_perm:[3,3,3,3] row_mask:0xf bank_mask:0xf
    v_dot2c_f32_bf16_dpp v47, v21, v113 quad_perm:[3,3,3,3] row_mask:0xf bank_mask:0xf
    v_dot2c_f32_bf16_dpp v49, v21, v114 quad_perm:[3,3,3,3] row_mask:0xf bank_mask:0xf
    v_dot2c_f32_bf16_dpp v51, v21, v115 quad_perm:[3,3,3,3] row_mask:0xf bank_mask:0xf
    v_permlane32_swap_b32 v44, v48
    s_nop 0
    v_permlane32_swap_b32 v45, v49
    v_permlane32_swap_b32 v46, v50
    v_permlane32_swap_b32 v47, v51
    v_pk_add_f32 v[44:45], v[44:45], v[48:49]
    v_pk_add_f32 v[46:47], v[46:47], v[50:51]
    s_nop 1
    v_permlane16_swap_b32 v44, v46
    v_permlane16_swap_b32 v45, v47
    v_pk_add_f32 v[44:45], v[44:45], v[46:47]
    s_nop 1
    v_add_f32_dpp v45, v45, v45 row_ror:8 row_mask:0xf bank_mask:0xc
    s_nop 1
    v_add_f32_dpp v45, v44, v44 row_ror:8 row_mask:0xf bank_mask:0x3
    s_cmp_eq_u32 s3, 0
    s_cbranch_scc1 L_rB
    v_and_b32 v45, -2, v45
    ds_write_b32 v77, v45 offset:6400
    s_branch L_finB
L_rB:
    ds_read_b32 v46, v11 offset:6656
    ds_read_b32 v47, v11 offset:6912
    ds_read_b32 v48, v11 offset:7168
    s_sub_u32 s91, s91, 1
    s_cmp_gt_i32 s91, 0
    s_cselect_b64 s[70:71], -1, 0
    s_waitcnt lgkmcnt(0)
    v_max3_u32 v2, v46, v47, v48
    v_add_f32 v49, v45, v46
    v_add_f32 v50, v47, v48
    v_cmp_eq_u32 vcc, -1, v2
    v_add_f32 v49, v49, v50
    v_and_or_b32 v49, v49, s31, v94
    s_and_b64 vcc, vcc, s[70:71]
    s_cbranch_scc1 L_rB
    buffer_store_dword v49, v11, s[60:63], s88 offen sc1
L_nyB:
    s_or_b32 s9, s9, s3
    s_cbranch_scc1 L_finB
    s_waitcnt vmcnt(0)
L_fB:
    s_wqm_b64 exec, exec
    buffer_load_dwordx4 v[52:55], v13, s[60:63], s10 offen sc1
    s_sub_u32 s91, s91, 1
    s_cmp_gt_i32 s91, 0
    s_cselect_b64 s[70:71], -1, 0
    s_waitcnt vmcnt(0)
    v_xor_b32 v52, s69, v52
    v_xor_b32 v53, s92, v53
    v_xor_b32 v54, s93, v54
    v_xor_b32 v55, s94, v55
    v_or3_b32 v2, v52, v53, v54
    v_bitop3_b32 v2, v2, v55, s31 bitop3:0x54
    v_cmp_ne_u32 vcc, 0, v2
    s_nop 1
    s_and_b64 exec, vcc, s[70:71]
    s_cbranch_scc1 L_fB
    s_mov_b64 exec, -1
    s_nop 0
    v_permlane32_swap_b32 v52, v54
    v_permlane32_swap_b32 v53, v55
    v_pk_add_f32 v[52:53], v[52:53], v[54:55]
    s_nop 1
    v_permlane16_swap_b32 v52, v53
    v_add_f32 v52, v52, v53
    s_nop 1
    v_add_f32_dpp v52, v52, v52 row_ror:8 row_mask:0xf bank_mask:0xf
    s_nop 1
    v_add_f32_dpp v52, v52, v52 row_ror:4 row_mask:0xf bank_mask:0xf
    s_nop 1
    v_add_f32_dpp v52, v52, v52 quad_perm:[2,3,0,1] row_mask:0xf bank_mask:0xf
    v_cvt_pk_bf16_f32 v4, v52, 0
    s_mov_b64 exec, s[14:15]
    buffer_store_short v4, v76, s[64:67], s12 offen
L_finB:
L_end:
    s_endpgm
.fill 64, 4, 0xbf800000
.section .rodata,"a"
.p2align 6
.amdhsa_kernel concat_heads__sliding_block_cached__mha_block_cached__decode_kernel
  .amdhsa_next_free_vgpr 256
  .amdhsa_next_free_sgpr 102
  .amdhsa_accum_offset 256
  .amdhsa_group_segment_fixed_size 0
  .amdhsa_kernarg_size 104
  .amdhsa_user_sgpr_count 2
  .amdhsa_user_sgpr_kernarg_segment_ptr 1
  .amdhsa_system_sgpr_workgroup_id_x 1
.end_amdhsa_kernel
```
